```python
import torch

def _softmax(x, axis=-1):
    return torch.softmax(x, dim=axis)
def _gelu(x):
    return torch.nn.functional.gelu(x, approximate="tanh")
def _silu(x):
    return torch.nn.functional.silu(x)
def _sigmoid(x):
    return torch.sigmoid(x)
def _layernorm(x, axis=-1, eps=1e-5):
    m = x.mean(dim=axis, keepdim=True)
    v = x.var(dim=axis, keepdim=True, unbiased=False)
    return (x - m) / torch.sqrt(v + eps)
def _scatter_add(tgt, idx, src, axis=0):
    return tgt.clone().index_add_(axis, idx, src)
def _segment_sum(src, seg, n):
    out = torch.zeros((n,) + src.shape[1:], dtype=src.dtype)
    return out.index_add_(0, seg, src)
def _pad(x, pw):
    flat = tuple(v for pair in reversed(pw) for v in pair)
    return torch.nn.functional.pad(x, flat)

kernel_name = 'concat_heads__gqa_block_cached__gqa_block_cached__near_ridge'

def setup_inputs():

    _w = (lambda a: (lambda t: t.to(torch.bfloat16) if t.is_floating_point() else t)(torch.as_tensor(a)))
    def _A_setup():
        B, Sq, D = 8, 64, 512
        Hq, Hkv, Sk, Dh = 32, 8, 512, 128
        assert Hq % Hkv == 0, (Hq, Hkv)
        return {
            "x": _w((lambda *s: torch.randn(*s, dtype=torch.bfloat16) * 0.8)(B, Sq, D)),
            "k_cache": _w((lambda *s: torch.randn(*s, dtype=torch.bfloat16) * 0.8)(B, Hkv, Sk, Dh)),
            "v_cache": _w((lambda *s: torch.randn(*s, dtype=torch.bfloat16) * 0.05)(B, Hkv, Sk, Dh)),
            "wq": _w((lambda *s: torch.randn(*s, dtype=torch.bfloat16) * 0.8)(D, Hq * Dh) * (D ** -0.5)),
            "wo": _w((lambda *s: torch.randn(*s, dtype=torch.bfloat16) * 0.05)(Hq * Dh, D) * ((Hq * Dh) ** -0.5)),
        }
    _A_in = _A_setup()

    def _B_setup():
        B, Sq, D = 8, 64, 512
        Hq, Hkv, Sk, Dh = 32, 8, 512, 128
        assert Hq % Hkv == 0, (Hq, Hkv)
        return {
            "x": _w((lambda *s: torch.randn(*s, dtype=torch.bfloat16) * 0.8)(B, Sq, D)),
            "k_cache": _w((lambda *s: torch.randn(*s, dtype=torch.bfloat16) * 0.8)(B, Hkv, Sk, Dh)),
            "v_cache": _w((lambda *s: torch.randn(*s, dtype=torch.bfloat16) * 0.05)(B, Hkv, Sk, Dh)),
            "wq": _w((lambda *s: torch.randn(*s, dtype=torch.bfloat16) * 0.8)(D, Hq * Dh) * (D ** -0.5)),
            "wo": _w((lambda *s: torch.randn(*s, dtype=torch.bfloat16) * 0.05)(Hq * Dh, D) * ((Hq * Dh) ** -0.5)),
        }
    _B_in = _B_setup()

    return {
        "A_x": _A_in["x"],
        "A_k_cache": _A_in["k_cache"],
        "A_v_cache": _A_in["v_cache"],
        "A_wq": _A_in["wq"],
        "A_wo": _A_in["wo"],
        "B_x": _B_in["x"],
        "B_k_cache": _B_in["k_cache"],
        "B_v_cache": _B_in["v_cache"],
        "B_wq": _B_in["wq"],
        "B_wo": _B_in["wo"],
    }

def reference(A_x, A_k_cache, A_v_cache, A_wq, A_wo, B_x, B_k_cache, B_v_cache, B_wq, B_wo):
    def _A_ref(x, k_cache, v_cache, wq, wo):
        B, Sq, D = x.shape
        Hq, Dh = 32, 128
        Hkv = k_cache.shape[1]
        rep = Hq // Hkv
        q = (lambda x, *d: x.permute(*d))((x @ wq).reshape(B, Sq, Hq, Dh), 0, 2, 1, 3)
        k = (lambda x, n, axis: torch.repeat_interleave(x, n, dim=axis))(k_cache, rep, axis=1)
        v = (lambda x, n, axis: torch.repeat_interleave(x, n, dim=axis))(v_cache, rep, axis=1)
        scores = torch.einsum("bhqd,bhkd->bhqk", q, k) * (Dh ** -0.5)
        p = _softmax(scores, axis=-1)
        o = torch.einsum("bhqk,bhkd->bhqd", p, v)
        return (lambda x, *d: x.permute(*d))(o, 0, 2, 1, 3).reshape(B, Sq, Hq * Dh) @ wo

    def _B_ref(x, k_cache, v_cache, wq, wo):
        B, Sq, D = x.shape
        Hq, Dh = 32, 128
        Hkv = k_cache.shape[1]
        rep = Hq // Hkv
        q = (lambda x, *d: x.permute(*d))((x @ wq).reshape(B, Sq, Hq, Dh), 0, 2, 1, 3)
        k = (lambda x, n, axis: torch.repeat_interleave(x, n, dim=axis))(k_cache, rep, axis=1)
        v = (lambda x, n, axis: torch.repeat_interleave(x, n, dim=axis))(v_cache, rep, axis=1)
        scores = torch.einsum("bhqd,bhkd->bhqk", q, k) * (Dh ** -0.5)
        p = _softmax(scores, axis=-1)
        o = torch.einsum("bhqk,bhkd->bhqd", p, v)
        return (lambda x, *d: x.permute(*d))(o, 0, 2, 1, 3).reshape(B, Sq, Hq * Dh) @ wo

    a = _A_ref(A_x, A_k_cache, A_v_cache, A_wq, A_wo)
    b = _B_ref(B_x, B_k_cache, B_v_cache, B_wq, B_wo)
    return torch.concatenate([a, b], axis=-1)
```

```asm
; @launch grid=(256,1,1) block=(512,1,1) lds=163840
.amdgcn_target "amdgcn-amd-amdhsa--gfx950"
.text
.globl concat_heads__gqa_block_cached__gqa_block_cached__near_ridge_kernel
.p2align 8
.type concat_heads__gqa_block_cached__gqa_block_cached__near_ridge_kernel,@function
concat_heads__gqa_block_cached__gqa_block_cached__near_ridge_kernel:
    s_cmp_ge_u32 s2, 256
    s_cbranch_scc1 L_end
    v_lshrrev_b32 v2, 6, v0
    s_and_b32 s43, s2, 7
    s_lshr_b32 s4, s43, 2
    s_mul_i32 s44, s4, 40
    s_add_u32 s56, s0, s44
    s_addc_u32 s57, s1, 0
    v_readfirstlane_b32 s3, v2
    s_nop 0
    s_cmp_ge_u32 s3, 4
    s_cbranch_scc1 L_helper
    v_and_b32 v1, 63, v0
    s_mov_b32 s10, 524288
    s_mov_b32 s11, 0x20000
    s_mov_b32 s14, 8388608
    s_mov_b32 s15, 0x20000
    s_mov_b32 s18, 8388608
    s_mov_b32 s19, 0x20000
    s_mov_b32 s22, 4194304
    s_mov_b32 s23, 0x20000
    s_mov_b32 s26, 4194304
    s_mov_b32 s27, 0x20000
    s_mov_b32 s30, 33554432
    s_mov_b32 s31, 0x20000
    s_mov_b32 s34, 1048576
    s_mov_b32 s35, 0x20000
    s_mov_b32 s38, 256
    s_mov_b32 s39, 0x20000
    s_and_b32 s43, s43, 3
    s_lshr_b32 s44, s2, 3
    s_and_b32 s5, s44, 7
    s_lshr_b32 s44, s44, 3
    s_lshl_b32 s43, s43, 2
    s_add_u32 s6, s43, s44
    s_lshl_b32 s40, s4, 3
    s_add_u32 s40, s40, s5
    s_lshr_b32 s43, s5, 2
    s_mul_i32 s43, s43, 8
    s_mul_i32 s44, s44, 4
    s_add_u32 s41, s43, s44
    s_and_b32 s41, s41, 15
    s_lshr_b32 s43, s5, 1
    s_mul_i32 s43, s43, 4
    s_add_u32 s7, s6, s43
    s_and_b32 s7, s7, 15
    s_lshr_b32 s42, s7, 1
    s_add_u32 s42, s42, 1
    s_and_b32 s42, s42, 7
    s_getpc_b64 s[92:93]
    s_and_b32 s92, s92, 0xfffff000
    s_mov_b32 s94, L_end-L_pg1+4096
    s_mov_b32 s95, 0x20000
    s_lshr_b32 s43, s2, 3
    s_lshl_b32 s43, s43, 10
    v_lshlrev_b32 v48, 7, v1
    v_lshrrev_b32 v49, 3, v1
    v_lshl_or_b32 v48, v49, 28, v48
    s_cmp_lg_u32 s3, 0
    s_cbranch_scc1 L_w0_pf
    buffer_load_dword v242, v48, s[92:95], s43 offen
L_w0_pf:
    s_and_b32 s43, s3, 1
    s_lshr_b32 s44, s3, 1
    v_lshrrev_b32 v48, 5, v1
    v_bfe_u32 v49, v1, 2, 2
    v_bfe_u32 v50, v1, 4, 1
    v_and_b32 v51, 1, v1
    v_bfe_u32 v52, v1, 1, 1
    v_and_b32 v53, 31, v1
    v_lshl_add_u32 v54, v48, 3, v49
    v_lshlrev_b32 v54, 9, v54
    s_lshl_b32 s45, s44, 8
    v_lshl_add_u32 v54, v50, 5, v54
    v_lshl_add_u32 v54, v51, 4, v54
    v_lshl_add_u32 v54, v52, 3, v54
    v_add_u32 v54, s45, v54
    v_lshl_add_u32 v2, v49, 6, v54
    v_xor_b32 v3, 64, v2
    v_xor_b32 v4, 128, v2
    v_xor_b32 v5, 192, v2
    v_add_u32 v6, 0x10000, v2
    v_add_u32 v7, 0x10000, v3
    v_add_u32 v8, 0x10000, v4
    v_add_u32 v9, 0x10000, v5
    s_lshl_b32 s45, s43, 12
    s_add_u32 s45, s45, 98304
    v_lshl_add_u32 v54, v53, 7, s45
    v_bfe_u32 v55, v1, 1, 3
    v_xor_b32 v55, v55, v48
    v_lshl_add_u32 v10, v55, 4, v54
    v_xor_b32 v11, 32, v10
    v_xor_b32 v12, 64, v10
    v_xor_b32 v13, 96, v10
    v_lshlrev_b32 v54, 8, v53
    v_add_u32 v54, 98304, v54
    v_and_b32 v55, 15, v1
    v_xor_b32 v55, v55, v48
    v_lshl_add_u32 v14, v55, 4, v54
    v_xor_b32 v15, 32, v14
    v_xor_b32 v16, 64, v14
    v_xor_b32 v17, 96, v14
    v_xor_b32 v18, 128, v14
    v_xor_b32 v19, 160, v14
    v_xor_b32 v20, 192, v14
    v_xor_b32 v21, 224, v14
    v_lshl_add_u32 v54, v48, 2, v49
    v_lshlrev_b32 v55, 8, v54
    v_add_u32 v55, 131072, v55
    v_lshl_add_u32 v55, v50, 5, v55
    v_lshl_add_u32 v55, v52, 4, v55
    v_lshl_add_u32 v55, v51, 3, v55
    v_lshl_add_u32 v22, v49, 6, v55
    v_xor_b32 v23, 64, v22
    v_xor_b32 v24, 128, v22
    v_xor_b32 v25, 192, v22
    v_lshlrev_b32 v54, 7, v54
    v_lshl_add_u32 v54, v51, 5, v54
    v_lshl_add_u32 v54, v50, 4, v54
    v_lshl_add_u32 v54, v52, 3, v54
    v_lshrrev_b32 v55, 1, v49
    v_xor_b32 v55, s44, v55
    v_lshl_add_u32 v54, v55, 6, v54
    s_lshl_b32 s45, s44, 14
    v_add_u32 v26, s45, v54
    v_xor_b32 v27, 0x4000, v26
    v_add_u32 v28, 65536, v26
    v_add_u32 v29, 65536, v27
    v_add_u32 v30, 131072, v26
    v_add_u32 v31, 131072, v27
    s_load_dwordx2 s[12:13], s[56:57], 8
    s_load_dwordx2 s[16:17], s[56:57], 16
    s_load_dwordx2 s[24:25], s[56:57], 32
    s_load_dwordx2 s[32:33], s[0:1], 80
    s_load_dwordx2 s[36:37], s[0:1], 88
    s_load_dwordx2 s[28:29], s[0:1], 96
    s_lshl_b32 s45, s3, 13
    s_add_u32 s45, s45, 131072
    v_lshl_add_u32 v34, v1, 4, s45
    v_xor_b32 v35, 0x4000, v34
    s_lshl_b32 s45, s40, 20
    s_lshl_b32 s46, s43, 16
    s_add_u32 s45, s45, s46
    s_and_b32 s46, s7, 1
    s_lshl_b32 s46, s46, 12
    s_add_u32 s45, s45, s46
    s_lshl_b32 s46, s44, 11
    s_add_u32 s45, s45, s46
    v_lshl_add_u32 v32, v1, 4, s45
    s_lshl_b32 s45, s40, 4
    s_add_u32 s45, s45, s43
    s_lshl_b32 s45, s45, 5
    s_and_b32 s46, s7, 1
    s_lshl_b32 s46, s46, 1
    s_add_u32 s45, s45, s46
    s_add_u32 s45, s45, s44
    s_lshl_b32 s45, s45, 2
    s_add_u32 s45, s45, 16777216
    v_min_u32 v54, 1, v1
    v_lshlrev_b32 v54, 31, v54
    v_add_u32 v33, s45, v54
    s_lshl_b32 s45, s40, 4
    v_add_u32 v241, s45, v54
    v_mov_b32 v240, 1
    v_mov_b32 v36, 0
    v_mov_b32 v37, 0
    v_mov_b32 v224, 0
    v_mov_b32 v225, 0
    v_mov_b32 v226, 0
    v_mov_b32 v227, 0
    s_mov_b32 s54, 0x3e0293ee
    s_mov_b32 s55, 0x3e0293ee
    s_mov_b32 s53, 0
    s_lshl_b32 s45, s40, 11
    s_add_u32 s45, s45, 16777216
    s_or_b32 s100, s3, s6
    v_lshl_add_u32 v38, v1, 4, s45
    s_waitcnt lgkmcnt(0)
    s_cmp_lg_u32 s100, 0
    s_cbranch_scc1 L_w0_clr
    buffer_store_dwordx4 v[224:227], v38, s[28:31], 0 offen sc1
    buffer_store_dwordx4 v[224:227], v38, s[28:31], 0 offen offset:1024 sc1
L_w0_clr:
    s_xor_b32 s56, s3, 1
    s_cmp_lg_u32 s56, 0
    s_cbranch_scc1 L_w0_tlb
    s_lshr_b32 s45, s6, 1
    s_lshl_b32 s46, s5, 3
    s_add_u32 s45, s45, s46
    s_lshl_b32 s45, s45, 17
    s_lshl_b32 s46, s6, 18
    v_min_u32 v39, 1, v1
    v_lshlrev_b32 v39, 31, v39
    buffer_load_dword v243, v39, s[12:15], s45 offen
    buffer_load_dword v243, v39, s[16:19], s45 offen
    buffer_load_dword v243, v39, s[24:27], s46 offen
    s_lshl_b32 s45, s40, 20
    s_lshl_b32 s46, s5, 17
    buffer_load_dword v243, v39, s[28:31], s45 offen
    buffer_load_dword v243, v39, s[32:35], s46 offen
    s_mov_b32 s45, 16842752
    buffer_load_dword v243, v39, s[28:31], s45 offen
L_w0_tlb:
    s_branch L_compute
L_helper:
    s_load_dwordx8 s[80:87], s[56:57], 0
    v_and_b32 v1, 63, v0
    s_mov_b32 s10, 524288
    s_mov_b32 s11, 0x20000
    s_mov_b32 s14, 8388608
    s_mov_b32 s15, 0x20000
    s_mov_b32 s18, 8388608
    s_mov_b32 s19, 0x20000
    s_mov_b32 s22, 4194304
    s_mov_b32 s23, 0x20000
    s_mov_b32 s26, 4194304
    s_mov_b32 s27, 0x20000
    s_mov_b32 s30, 33554432
    s_mov_b32 s31, 0x20000
    s_mov_b32 s34, 1048576
    s_mov_b32 s35, 0x20000
    s_mov_b32 s38, 256
    s_mov_b32 s39, 0x20000
    s_and_b32 s43, s43, 3
    s_lshr_b32 s44, s2, 3
    s_and_b32 s5, s44, 7
    s_lshr_b32 s44, s44, 3
    s_lshl_b32 s43, s43, 2
    s_add_u32 s6, s43, s44
    s_lshl_b32 s40, s4, 3
    s_add_u32 s40, s40, s5
    s_lshr_b32 s43, s5, 2
    s_mul_i32 s43, s43, 8
    s_mul_i32 s44, s44, 4
    s_add_u32 s41, s43, s44
    s_and_b32 s41, s41, 15
    s_lshr_b32 s43, s5, 1
    s_mul_i32 s43, s43, 4
    s_add_u32 s7, s6, s43
    s_and_b32 s7, s7, 15
    s_lshr_b32 s42, s7, 1
    s_add_u32 s42, s42, 1
    s_and_b32 s42, s42, 7
    s_sub_u32 s46, s3, 4
    v_lshrrev_b32 v20, 3, v1
    s_lshl_b32 s43, s46, 4
    s_lshl_b32 s44, s5, 6
    s_add_u32 s43, s43, s44
    v_add_lshl_u32 v2, v20, s43, 10
    v_lshrrev_b32 v21, 4, v1
    v_and_b32 v22, 7, v1
    v_xor_b32 v22, v22, v21
    v_xor_b32 v23, 4, v22
    v_lshl_add_u32 v3, v23, 4, v2
    v_add_u32 v3, 7168, v3
    v_lshl_add_u32 v2, v22, 4, v2
    v_lshrrev_b32 v22, 5, v1
    s_lshl_b32 s43, s46, 3
    s_lshl_b32 s44, s6, 9
    v_add_lshl_u32 v23, v22, s43, 13
    v_add_u32 v23, s44, v23
    v_lshlrev_b32 v22, 2, v22
    v_and_b32 v19, 31, v1
    v_xor_b32 v22, v22, v19
    v_lshl_add_u32 v4, v22, 4, v23
    v_xor_b32 v22, 8, v22
    v_lshl_add_u32 v5, v22, 4, v23
    v_add_u32 v6, 30720, v4
    v_add_u32 v7, 46080, v5
    v_add_u32 v5, 15360, v5
    s_lshl_b32 s48, s41, 18
    s_lshl_b32 s47, s41, 6
    s_lshl_b32 s51, s46, 11
    s_lshl_b32 s52, s46, 12
    s_waitcnt lgkmcnt(0)
    s_mov_b64 s[8:9], s[80:81]
    s_mov_b64 s[20:21], s[86:87]
    s_mov_b64 s[12:13], s[82:83]
    s_mov_b64 s[16:17], s[84:85]
    s_add_u32 m0, s51, 98304
    s_nop 0
    buffer_load_dwordx4 v2, s[8:11], s47 offen lds
    buffer_load_dwordx4 v3, s[8:11], s47 offen offset:1024 lds
    s_add_u32 s47, s47, 128
    s_and_b32 s47, s47, 0x3ff
    s_add_u32 m0, s52, 0
    s_nop 0
    buffer_load_dwordx4 v4, s[20:23], s48 offen lds
    buffer_load_dwordx4 v5, s[20:23], s48 offen offset:1024 lds
    buffer_load_dwordx4 v6, s[20:23], s48 offen offset:2048 lds
    buffer_load_dwordx4 v7, s[20:23], s48 offen offset:3072 lds
    s_add_u32 s48, s48, 0x40000
    s_and_b32 s48, s48, 0x3fffff
    s_add_u32 m0, s52, 16384
    s_nop 0
    buffer_load_dwordx4 v4, s[20:23], s48 offen lds
    buffer_load_dwordx4 v5, s[20:23], s48 offen offset:1024 lds
    buffer_load_dwordx4 v6, s[20:23], s48 offen offset:2048 lds
    buffer_load_dwordx4 v7, s[20:23], s48 offen offset:3072 lds
    s_add_u32 s48, s48, 0x40000
    s_and_b32 s48, s48, 0x3fffff
    s_load_dwordx2 s[24:25], s[56:57], 32
    s_load_dwordx2 s[32:33], s[0:1], 80
    s_load_dwordx2 s[28:29], s[0:1], 96
    s_lshr_b32 s43, s6, 1
    s_lshl_b32 s44, s5, 3
    s_add_u32 s43, s43, s44
    s_lshl_b32 s43, s43, 17
    s_lshl_b32 s44, s46, 11
    s_add_u32 s43, s43, s44
    s_and_b32 s44, s46, 1
    s_lshl_b32 s44, s44, 3
    v_lshlrev_b32 v23, 8, v21
    v_add_u32 v23, s43, v23
    v_and_b32 v19, 15, v1
    v_add_u32 v22, s44, v21
    v_xor_b32 v22, v22, v19
    v_lshl_add_u32 v8, v22, 4, v23
    v_xor_b32 v22, 4, v22
    v_lshl_add_u32 v9, v22, 4, v23
    v_lshlrev_b32 v22, 2, v21
    v_xor_b32 v22, v22, v19
    v_lshl_add_u32 v10, v22, 4, v23
    s_lshr_b32 s43, s6, 1
    s_and_b32 s43, s43, 1
    s_lshl_b32 s43, s43, 3
    s_add_u32 s43, s43, s5
    s_mul_i32 s43, s43, 1
    s_lshl_b32 s96, s43, 13
    s_lshl_b32 s43, s46, 5
    s_lshl_b32 s44, s6, 8
    s_add_u32 s43, s43, s44
    v_add_lshl_u32 v23, v20, s43, 10
    v_and_b32 v22, 1, v21
    v_lshlrev_b32 v22, 2, v22
    v_and_b32 v19, 7, v1
    v_xor_b32 v22, v22, v19
    v_lshl_add_u32 v12, v22, 4, v23
    v_add_u32 v13, 7168, v12
    v_add_u32 v14, 14336, v12
    v_add_u32 v15, 21504, v12
    v_lshl_add_u32 v40, v1, 4, s52
    v_add_u32 v41, 0x10000, v40
    s_lshl_b32 s43, s40, 4
    s_add_u32 s43, s43, s7
    s_lshl_b32 s44, s43, 7
    s_add_u32 s44, s44, 16777216
    s_lshl_b32 s43, s43, 16
    s_lshl_b32 s45, s46, 7
    v_and_b32 v22, 7, v1
    v_bfe_u32 v23, v1, 3, 1
    v_lshl_add_u32 v22, v23, 5, v22
    v_lshl_add_u32 v22, v22, 4, s45
    v_lshrrev_b32 v23, 4, v1
    v_lshl_add_u32 v16, v23, 10, v22
    v_add_u32 v16, s43, v16
    v_lshl_add_u32 v42, v23, 11, v22
    v_add_u32 v42, 98304, v42
    v_and_b32 v22, 31, v1
    v_lshl_add_u32 v17, v22, 2, s44
    s_lshl_b32 s43, s5, 1
    s_and_b32 s44, s7, 1
    s_add_u32 s43, s43, s44
    s_lshl_b32 s43, s43, 2
    s_add_u32 s43, s43, s46
    s_lshl_b32 s43, s43, 14
    s_lshl_b32 s44, s4, 10
    s_add_u32 s43, s43, s44
    s_lshr_b32 s44, s7, 1
    s_lshl_b32 s44, s44, 7
    s_add_u32 s43, s43, s44
    v_lshl_add_u32 v18, v20, 11, s43
    v_and_b32 v22, 7, v1
    v_lshl_add_u32 v18, v22, 4, v18
    v_bfe_u32 v22, v1, 2, 1
    v_lshl_add_u32 v43, v22, 5, v20
    v_and_b32 v22, 1, v1
    v_lshl_add_u32 v43, v22, 4, v43
    v_bfe_u32 v22, v1, 1, 1
    v_lshl_add_u32 v43, v22, 3, v43
    v_lshlrev_b32 v43, 2, v43
    v_and_b32 v19, 3, v1
    v_lshlrev_b32 v19, 13, v19
    v_add_u32 v19, 131072, v19
    s_waitcnt lgkmcnt(0)
    s_waitcnt vmcnt(4)
    s_barrier
    s_add_u32 m0, s51, 106496
    s_nop 0
    buffer_load_dwordx4 v2, s[8:11], s47 offen lds
    buffer_load_dwordx4 v3, s[8:11], s47 offen offset:1024 lds
    s_add_u32 s47, s47, 128
    s_and_b32 s47, s47, 0x3ff
    s_add_u32 m0, s52, 32768
    s_nop 0
    buffer_load_dwordx4 v4, s[20:23], s48 offen lds
    buffer_load_dwordx4 v5, s[20:23], s48 offen offset:1024 lds
    buffer_load_dwordx4 v6, s[20:23], s48 offen offset:2048 lds
    buffer_load_dwordx4 v7, s[20:23], s48 offen offset:3072 lds
    s_add_u32 s48, s48, 0x40000
    s_and_b32 s48, s48, 0x3fffff
    s_waitcnt vmcnt(6)
    s_barrier
    s_add_u32 m0, s52, 49152
    s_nop 0
    buffer_load_dwordx4 v4, s[20:23], s48 offen lds
    buffer_load_dwordx4 v5, s[20:23], s48 offen offset:1024 lds
    buffer_load_dwordx4 v6, s[20:23], s48 offen offset:2048 lds
    buffer_load_dwordx4 v7, s[20:23], s48 offen offset:3072 lds
    s_add_u32 s48, s48, 0x40000
    s_and_b32 s48, s48, 0x3fffff
    s_waitcnt vmcnt(4)
    s_barrier
    s_add_u32 m0, s51, 131072
    s_nop 0
    buffer_load_dwordx4 v2, s[8:11], s47 offen lds
    buffer_load_dwordx4 v3, s[8:11], s47 offen offset:1024 lds
    s_add_u32 s47, s47, 128
    s_and_b32 s47, s47, 0x3ff
    s_add_u32 m0, s52, 65536
    s_nop 0
    buffer_load_dwordx4 v4, s[20:23], s48 offen lds
    buffer_load_dwordx4 v5, s[20:23], s48 offen offset:1024 lds
    buffer_load_dwordx4 v6, s[20:23], s48 offen offset:2048 lds
    buffer_load_dwordx4 v7, s[20:23], s48 offen offset:3072 lds
    s_add_u32 s48, s48, 0x40000
    s_and_b32 s48, s48, 0x3fffff
    s_add_u32 m0, s52, 81920
    s_nop 0
    buffer_load_dwordx4 v4, s[20:23], s48 offen lds
    buffer_load_dwordx4 v5, s[20:23], s48 offen offset:1024 lds
    buffer_load_dwordx4 v6, s[20:23], s48 offen offset:2048 lds
    buffer_load_dwordx4 v7, s[20:23], s48 offen offset:3072 lds
    s_add_u32 s48, s48, 0x40000
    s_and_b32 s48, s48, 0x3fffff
    s_add_u32 m0, s51, 114688
    s_nop 0
    buffer_load_dwordx4 v2, s[8:11], s47 offen lds
    buffer_load_dwordx4 v3, s[8:11], s47 offen offset:1024 lds
    s_add_u32 s47, s47, 128
    s_and_b32 s47, s47, 0x3ff
    s_waitcnt vmcnt(12)
    s_barrier
    s_add_u32 m0, s52, 0
    s_nop 0
    buffer_load_dwordx4 v4, s[20:23], s48 offen lds
    buffer_load_dwordx4 v5, s[20:23], s48 offen offset:1024 lds
    buffer_load_dwordx4 v6, s[20:23], s48 offen offset:2048 lds
    buffer_load_dwordx4 v7, s[20:23], s48 offen offset:3072 lds
    s_add_u32 s48, s48, 0x40000
    s_and_b32 s48, s48, 0x3fffff
    s_waitcnt vmcnt(10)
    s_barrier
    s_add_u32 m0, s52, 16384
    s_nop 0
    buffer_load_dwordx4 v4, s[20:23], s48 offen lds
    buffer_load_dwordx4 v5, s[20:23], s48 offen offset:1024 lds
    buffer_load_dwordx4 v6, s[20:23], s48 offen offset:2048 lds
    buffer_load_dwordx4 v7, s[20:23], s48 offen offset:3072 lds
    s_add_u32 s48, s48, 0x40000
    s_and_b32 s48, s48, 0x3fffff
    s_add_u32 m0, s51, 139264
    s_nop 0
    buffer_load_dwordx4 v2, s[8:11], s47 offen lds
    buffer_load_dwordx4 v3, s[8:11], s47 offen offset:1024 lds
    s_add_u32 s47, s47, 128
    s_and_b32 s47, s47, 0x3ff
    s_waitcnt vmcnt(12)
    s_barrier
    s_add_u32 m0, s52, 32768
    s_nop 0
    buffer_load_dwordx4 v4, s[20:23], s48 offen lds
    buffer_load_dwordx4 v5, s[20:23], s48 offen offset:1024 lds
    buffer_load_dwordx4 v6, s[20:23], s48 offen offset:2048 lds
    buffer_load_dwordx4 v7, s[20:23], s48 offen offset:3072 lds
    s_add_u32 s48, s48, 0x40000
    s_and_b32 s48, s48, 0x3fffff
    s_waitcnt vmcnt(10)
    s_barrier
    s_add_u32 m0, s52, 49152
    s_nop 0
    buffer_load_dwordx4 v4, s[20:23], s48 offen lds
    buffer_load_dwordx4 v5, s[20:23], s48 offen offset:1024 lds
    buffer_load_dwordx4 v6, s[20:23], s48 offen offset:2048 lds
    buffer_load_dwordx4 v7, s[20:23], s48 offen offset:3072 lds
    s_add_u32 s48, s48, 0x40000
    s_and_b32 s48, s48, 0x3fffff
    s_add_u32 m0, s51, 122880
    s_nop 0
    buffer_load_dwordx4 v2, s[8:11], s47 offen lds
    buffer_load_dwordx4 v3, s[8:11], s47 offen offset:1024 lds
    s_add_u32 s47, s47, 128
    s_and_b32 s47, s47, 0x3ff
    s_branch L_h2
.p2align 12
L_pg1:
L_mk1:
    s_cbranch_execz L_rt1
L_h2:
    s_waitcnt vmcnt(12)
    s_barrier
    s_add_u32 m0, s52, 65536
    s_nop 0
    buffer_load_dwordx4 v4, s[20:23], s48 offen lds
    buffer_load_dwordx4 v5, s[20:23], s48 offen offset:1024 lds
    buffer_load_dwordx4 v6, s[20:23], s48 offen offset:2048 lds
    buffer_load_dwordx4 v7, s[20:23], s48 offen offset:3072 lds
    s_add_u32 s48, s48, 0x40000
    s_and_b32 s48, s48, 0x3fffff
    s_waitcnt vmcnt(10)
    s_barrier
    s_add_u32 m0, s52, 81920
    s_nop 0
    buffer_load_dwordx4 v4, s[20:23], s48 offen lds
    buffer_load_dwordx4 v5, s[20:23], s48 offen offset:1024 lds
    buffer_load_dwordx4 v6, s[20:23], s48 offen offset:2048 lds
    buffer_load_dwordx4 v7, s[20:23], s48 offen offset:3072 lds
    s_add_u32 s48, s48, 0x40000
    s_and_b32 s48, s48, 0x3fffff
    s_add_u32 m0, s51, 147456
    s_nop 0
    buffer_load_dwordx4 v2, s[8:11], s47 offen lds
    buffer_load_dwordx4 v3, s[8:11], s47 offen offset:1024 lds
    s_add_u32 s47, s47, 128
    s_and_b32 s47, s47, 0x3ff
    s_waitcnt vmcnt(12)
    s_barrier
    s_add_u32 m0, s52, 0
    s_nop 0
    buffer_load_dwordx4 v4, s[20:23], s48 offen lds
    buffer_load_dwordx4 v5, s[20:23], s48 offen offset:1024 lds
    buffer_load_dwordx4 v6, s[20:23], s48 offen offset:2048 lds
    buffer_load_dwordx4 v7, s[20:23], s48 offen offset:3072 lds
    s_add_u32 s48, s48, 0x40000
    s_and_b32 s48, s48, 0x3fffff
    s_waitcnt vmcnt(10)
    s_barrier
    s_add_u32 m0, s52, 16384
    s_nop 0
    buffer_load_dwordx4 v4, s[20:23], s48 offen lds
    buffer_load_dwordx4 v5, s[20:23], s48 offen offset:1024 lds
    buffer_load_dwordx4 v6, s[20:23], s48 offen offset:2048 lds
    buffer_load_dwordx4 v7, s[20:23], s48 offen offset:3072 lds
    s_add_u32 s48, s48, 0x40000
    s_and_b32 s48, s48, 0x3fffff
    s_add_u32 m0, s51, 155648
    s_nop 0
    buffer_load_dwordx4 v2, s[8:11], s47 offen lds
    buffer_load_dwordx4 v3, s[8:11], s47 offen offset:1024 lds
    s_waitcnt vmcnt(12)
    s_barrier
    s_add_u32 m0, s52, 32768
    s_nop 0
    buffer_load_dwordx4 v4, s[20:23], s48 offen lds
    buffer_load_dwordx4 v5, s[20:23], s48 offen offset:1024 lds
    buffer_load_dwordx4 v6, s[20:23], s48 offen offset:2048 lds
    buffer_load_dwordx4 v7, s[20:23], s48 offen offset:3072 lds
    s_add_u32 s48, s48, 0x40000
    s_and_b32 s48, s48, 0x3fffff
    s_waitcnt vmcnt(10)
    s_barrier
    s_add_u32 m0, s52, 49152
    s_nop 0
    buffer_load_dwordx4 v4, s[20:23], s48 offen lds
    buffer_load_dwordx4 v5, s[20:23], s48 offen offset:1024 lds
    buffer_load_dwordx4 v6, s[20:23], s48 offen offset:2048 lds
    buffer_load_dwordx4 v7, s[20:23], s48 offen offset:3072 lds
    s_add_u32 m0, s51, 98304
    s_add_u32 s49, s96, 0
    s_and_b32 s49, s49, 0x1ffff
    buffer_load_dwordx4 v8, s[12:15], s49 offen lds
    buffer_load_dwordx4 v9, s[12:15], s49 offen offset:1024 lds
    s_waitcnt vmcnt(12)
    s_barrier
    s_add_u32 m0, s51, 106496
    s_add_u32 s49, s96, 8192
    s_and_b32 s49, s49, 0x1ffff
    buffer_load_dwordx4 v8, s[12:15], s49 offen lds
    buffer_load_dwordx4 v9, s[12:15], s49 offen offset:1024 lds
    s_add_u32 m0, s51, 131072
    s_add_u32 s49, s96, 0
    s_and_b32 s49, s49, 0x1ffff
    buffer_load_dwordx4 v10, s[16:19], s49 offen lds
    buffer_load_dwordx4 v10, s[16:19], s49 offen offset:1024 lds
    s_waitcnt vmcnt(10)
    s_barrier
    s_add_u32 m0, s51, 114688
    s_add_u32 s49, s96, 16384
    s_and_b32 s49, s49, 0x1ffff
    buffer_load_dwordx4 v8, s[12:15], s49 offen lds
    buffer_load_dwordx4 v9, s[12:15], s49 offen offset:1024 lds
    s_add_u32 m0, s51, 139264
    s_add_u32 s49, s96, 8192
    s_and_b32 s49, s49, 0x1ffff
    buffer_load_dwordx4 v10, s[16:19], s49 offen lds
    buffer_load_dwordx4 v10, s[16:19], s49 offen offset:1024 lds
    s_add_u32 m0, s51, 122880
    s_add_u32 s49, s96, 24576
    s_and_b32 s49, s49, 0x1ffff
    buffer_load_dwordx4 v8, s[12:15], s49 offen lds
    buffer_load_dwordx4 v9, s[12:15], s49 offen offset:1024 lds
    s_waitcnt vmcnt(12)
    s_barrier
    s_add_u32 m0, s51, 147456
    s_add_u32 s49, s96, 16384
    s_and_b32 s49, s49, 0x1ffff
    buffer_load_dwordx4 v10, s[16:19], s49 offen lds
    buffer_load_dwordx4 v10, s[16:19], s49 offen offset:1024 lds
    s_waitcnt vmcnt(12)
    s_barrier
    s_add_u32 m0, s51, 155648
    s_add_u32 s49, s96, 24576
    s_and_b32 s49, s49, 0x1ffff
    buffer_load_dwordx4 v10, s[16:19], s49 offen lds
    buffer_load_dwordx4 v10, s[16:19], s49 offen offset:1024 lds
    s_waitcnt vmcnt(10)
    s_barrier
    s_waitcnt vmcnt(6)
    s_barrier
    s_add_u32 m0, s51, 98304
    s_add_u32 s49, s96, 32768
    s_and_b32 s49, s49, 0x1ffff
    buffer_load_dwordx4 v8, s[12:15], s49 offen lds
    buffer_load_dwordx4 v9, s[12:15], s49 offen offset:1024 lds
    s_add_u32 m0, s51, 106496
    s_add_u32 s49, s96, 40960
    s_and_b32 s49, s49, 0x1ffff
    buffer_load_dwordx4 v8, s[12:15], s49 offen lds
    buffer_load_dwordx4 v9, s[12:15], s49 offen offset:1024 lds
    s_waitcnt vmcnt(6)
    s_barrier
    s_add_u32 m0, s51, 131072
    s_add_u32 s49, s96, 32768
    s_and_b32 s49, s49, 0x1ffff
    buffer_load_dwordx4 v10, s[16:19], s49 offen lds
    buffer_load_dwordx4 v10, s[16:19], s49 offen offset:1024 lds
    s_add_u32 m0, s51, 114688
    s_add_u32 s49, s96, 49152
    s_and_b32 s49, s49, 0x1ffff
    buffer_load_dwordx4 v8, s[12:15], s49 offen lds
    buffer_load_dwordx4 v9, s[12:15], s49 offen offset:1024 lds
    s_waitcnt vmcnt(6)
    s_barrier
    s_add_u32 m0, s51, 139264
    s_add_u32 s49, s96, 40960
    s_and_b32 s49, s49, 0x1ffff
    buffer_load_dwordx4 v10, s[16:19], s49 offen lds
    buffer_load_dwordx4 v10, s[16:19], s49 offen offset:1024 lds
    s_add_u32 m0, s51, 122880
    s_add_u32 s49, s96, 57344
    s_and_b32 s49, s49, 0x1ffff
    buffer_load_dwordx4 v8, s[12:15], s49 offen lds
    buffer_load_dwordx4 v9, s[12:15], s49 offen offset:1024 lds
    s_waitcnt vmcnt(6)
    s_barrier
    s_add_u32 m0, s51, 147456
    s_add_u32 s49, s96, 49152
    s_and_b32 s49, s49, 0x1ffff
    buffer_load_dwordx4 v10, s[16:19], s49 offen lds
    buffer_load_dwordx4 v10, s[16:19], s49 offen offset:1024 lds
    s_add_u32 m0, s51, 98304
    s_add_u32 s49, s96, 65536
    s_and_b32 s49, s49, 0x1ffff
    buffer_load_dwordx4 v8, s[12:15], s49 offen lds
    buffer_load_dwordx4 v9, s[12:15], s49 offen offset:1024 lds
    s_waitcnt vmcnt(6)
    s_barrier
    s_add_u32 m0, s51, 155648
    s_add_u32 s49, s96, 57344
    s_and_b32 s49, s49, 0x1ffff
    buffer_load_dwordx4 v10, s[16:19], s49 offen lds
    buffer_load_dwordx4 v10, s[16:19], s49 offen offset:1024 lds
    s_add_u32 m0, s51, 106496
    s_add_u32 s49, s96, 73728
    s_and_b32 s49, s49, 0x1ffff
    buffer_load_dwordx4 v8, s[12:15], s49 offen lds
    buffer_load_dwordx4 v9, s[12:15], s49 offen offset:1024 lds
    s_waitcnt vmcnt(6)
    s_barrier
    s_add_u32 m0, s51, 131072
    s_add_u32 s49, s96, 65536
    s_and_b32 s49, s49, 0x1ffff
    buffer_load_dwordx4 v10, s[16:19], s49 offen lds
    buffer_load_dwordx4 v10, s[16:19], s49 offen offset:1024 lds
    s_add_u32 m0, s51, 114688
    s_add_u32 s49, s96, 81920
    s_and_b32 s49, s49, 0x1ffff
    buffer_load_dwordx4 v8, s[12:15], s49 offen lds
    buffer_load_dwordx4 v9, s[12:15], s49 offen offset:1024 lds
    s_add_u32 m0, s52, 0
    s_add_u32 s50, s42, 0
    s_and_b32 s50, s50, 7
    s_lshl_b32 s50, s50, 7
    buffer_load_dwordx4 v12, s[24:27], s50 offen lds
    buffer_load_dwordx4 v13, s[24:27], s50 offen offset:1024 lds
    buffer_load_dwordx4 v14, s[24:27], s50 offen offset:2048 lds
    buffer_load_dwordx4 v15, s[24:27], s50 offen offset:3072 lds
    s_waitcnt vmcnt(10)
    s_barrier
    s_add_u32 m0, s51, 139264
    s_add_u32 s49, s96, 73728
    s_and_b32 s49, s49, 0x1ffff
    buffer_load_dwordx4 v10, s[16:19], s49 offen lds
    buffer_load_dwordx4 v10, s[16:19], s49 offen offset:1024 lds
    s_add_u32 m0, s51, 122880
    s_add_u32 s49, s96, 90112
    s_and_b32 s49, s49, 0x1ffff
    buffer_load_dwordx4 v8, s[12:15], s49 offen lds
    buffer_load_dwordx4 v9, s[12:15], s49 offen offset:1024 lds
    s_waitcnt vmcnt(10)
    s_barrier
    s_add_u32 m0, s51, 147456
    s_add_u32 s49, s96, 81920
    s_and_b32 s49, s49, 0x1ffff
    buffer_load_dwordx4 v10, s[16:19], s49 offen lds
    buffer_load_dwordx4 v10, s[16:19], s49 offen offset:1024 lds
    s_add_u32 m0, s51, 98304
    s_add_u32 s49, s96, 98304
    s_and_b32 s49, s49, 0x1ffff
    buffer_load_dwordx4 v8, s[12:15], s49 offen lds
    buffer_load_dwordx4 v9, s[12:15], s49 offen offset:1024 lds
    s_add_u32 m0, s52, 16384
    s_add_u32 s50, s50, 0x20000
    buffer_load_dwordx4 v12, s[24:27], s50 offen lds
    buffer_load_dwordx4 v13, s[24:27], s50 offen offset:1024 lds
    buffer_load_dwordx4 v14, s[24:27], s50 offen offset:2048 lds
    buffer_load_dwordx4 v15, s[24:27], s50 offen offset:3072 lds
    s_waitcnt vmcnt(10)
    s_barrier
    s_add_u32 m0, s51, 155648
    s_add_u32 s49, s96, 90112
    s_and_b32 s49, s49, 0x1ffff
    buffer_load_dwordx4 v10, s[16:19], s49 offen lds
    buffer_load_dwordx4 v10, s[16:19], s49 offen offset:1024 lds
    s_add_u32 m0, s51, 106496
    s_add_u32 s49, s96, 106496
    s_and_b32 s49, s49, 0x1ffff
    buffer_load_dwordx4 v8, s[12:15], s49 offen lds
    buffer_load_dwordx4 v9, s[12:15], s49 offen offset:1024 lds
    s_waitcnt vmcnt(10)
    s_barrier
    s_add_u32 m0, s51, 131072
    s_add_u32 s49, s96, 98304
    s_and_b32 s49, s49, 0x1ffff
    buffer_load_dwordx4 v10, s[16:19], s49 offen lds
    buffer_load_dwordx4 v10, s[16:19], s49 offen offset:1024 lds
    s_add_u32 m0, s51, 114688
    s_add_u32 s49, s96, 114688
    s_and_b32 s49, s49, 0x1ffff
    buffer_load_dwordx4 v8, s[12:15], s49 offen lds
    buffer_load_dwordx4 v9, s[12:15], s49 offen offset:1024 lds
    s_add_u32 m0, s52, 32768
    s_add_u32 s50, s42, 1
    s_and_b32 s50, s50, 7
    s_lshl_b32 s50, s50, 7
    buffer_load_dwordx4 v12, s[24:27], s50 offen lds
    buffer_load_dwordx4 v13, s[24:27], s50 offen offset:1024 lds
    buffer_load_dwordx4 v14, s[24:27], s50 offen offset:2048 lds
    buffer_load_dwordx4 v15, s[24:27], s50 offen offset:3072 lds
    s_waitcnt vmcnt(10)
    s_barrier
    s_add_u32 m0, s51, 139264
    s_add_u32 s49, s96, 106496
    s_and_b32 s49, s49, 0x1ffff
    buffer_load_dwordx4 v10, s[16:19], s49 offen lds
    buffer_load_dwordx4 v10, s[16:19], s49 offen offset:1024 lds
    s_add_u32 m0, s51, 122880
    s_add_u32 s49, s96, 122880
    s_and_b32 s49, s49, 0x1ffff
    buffer_load_dwordx4 v8, s[12:15], s49 offen lds
    buffer_load_dwordx4 v9, s[12:15], s49 offen offset:1024 lds
    s_waitcnt vmcnt(10)
    s_barrier
    s_add_u32 m0, s51, 147456
    s_add_u32 s49, s96, 114688
    s_and_b32 s49, s49, 0x1ffff
    buffer_load_dwordx4 v10, s[16:19], s49 offen lds
    buffer_load_dwordx4 v10, s[16:19], s49 offen offset:1024 lds
    s_add_u32 m0, s52, 49152
    s_add_u32 s50, s50, 0x20000
    buffer_load_dwordx4 v12, s[24:27], s50 offen lds
    buffer_load_dwordx4 v13, s[24:27], s50 offen offset:1024 lds
    buffer_load_dwordx4 v14, s[24:27], s50 offen offset:2048 lds
    buffer_load_dwordx4 v15, s[24:27], s50 offen offset:3072 lds
    s_waitcnt vmcnt(8)
    s_barrier
    s_add_u32 m0, s51, 155648
    s_add_u32 s49, s96, 122880
    s_and_b32 s49, s49, 0x1ffff
    buffer_load_dwordx4 v10, s[16:19], s49 offen lds
    buffer_load_dwordx4 v10, s[16:19], s49 offen offset:1024 lds
    s_add_u32 m0, s52, 65536
    s_add_u32 s50, s42, 2
    s_and_b32 s50, s50, 7
    s_lshl_b32 s50, s50, 7
    buffer_load_dwordx4 v12, s[24:27], s50 offen lds
    buffer_load_dwordx4 v13, s[24:27], s50 offen offset:1024 lds
    buffer_load_dwordx4 v14, s[24:27], s50 offen offset:2048 lds
    buffer_load_dwordx4 v15, s[24:27], s50 offen offset:3072 lds
    s_waitcnt vmcnt(10)
    s_barrier
    s_add_u32 m0, s52, 81920
    s_add_u32 s50, s50, 0x20000
    buffer_load_dwordx4 v12, s[24:27], s50 offen lds
    buffer_load_dwordx4 v13, s[24:27], s50 offen offset:1024 lds
    buffer_load_dwordx4 v14, s[24:27], s50 offen offset:2048 lds
    buffer_load_dwordx4 v15, s[24:27], s50 offen offset:3072 lds
    s_waitcnt vmcnt(8)
    s_barrier
    s_add_u32 m0, s52, 98304
    s_add_u32 s50, s42, 3
    s_and_b32 s50, s50, 7
    s_lshl_b32 s50, s50, 7
    buffer_load_dwordx4 v12, s[24:27], s50 offen lds
    buffer_load_dwordx4 v13, s[24:27], s50 offen offset:1024 lds
    buffer_load_dwordx4 v14, s[24:27], s50 offen offset:2048 lds
    buffer_load_dwordx4 v15, s[24:27], s50 offen offset:3072 lds
    s_add_u32 m0, s52, 114688
    s_add_u32 s50, s50, 0x20000
    buffer_load_dwordx4 v12, s[24:27], s50 offen lds
    buffer_load_dwordx4 v13, s[24:27], s50 offen offset:1024 lds
    buffer_load_dwordx4 v14, s[24:27], s50 offen offset:2048 lds
    buffer_load_dwordx4 v15, s[24:27], s50 offen offset:3072 lds
    s_barrier
    s_barrier
    ds_read_b32 v22, v19
    s_waitcnt lgkmcnt(0)
    v_cmp_eq_u32 vcc, -1, v22
    s_cbranch_vccnz L_hslow
L_hgo:
    s_barrier
    s_add_u32 m0, s52, 131072
    s_add_u32 s50, s42, 4
    s_and_b32 s50, s50, 7
    s_lshl_b32 s50, s50, 7
    buffer_load_dwordx4 v12, s[24:27], s50 offen lds
    buffer_load_dwordx4 v13, s[24:27], s50 offen offset:1024 lds
    buffer_load_dwordx4 v14, s[24:27], s50 offen offset:2048 lds
    buffer_load_dwordx4 v15, s[24:27], s50 offen offset:3072 lds
    s_add_u32 m0, s52, 147456
    s_add_u32 s50, s50, 0x20000
    buffer_load_dwordx4 v12, s[24:27], s50 offen lds
    buffer_load_dwordx4 v13, s[24:27], s50 offen offset:1024 lds
    buffer_load_dwordx4 v14, s[24:27], s50 offen offset:2048 lds
    buffer_load_dwordx4 v15, s[24:27], s50 offen offset:3072 lds
    s_waitcnt vmcnt(16)
    s_barrier
    s_add_u32 m0, s52, 0
    s_add_u32 s50, s42, 5
    s_and_b32 s50, s50, 7
    s_lshl_b32 s50, s50, 7
    buffer_load_dwordx4 v12, s[24:27], s50 offen lds
    buffer_load_dwordx4 v13, s[24:27], s50 offen offset:1024 lds
    buffer_load_dwordx4 v14, s[24:27], s50 offen offset:2048 lds
    buffer_load_dwordx4 v15, s[24:27], s50 offen offset:3072 lds
    s_add_u32 m0, s52, 16384
    s_add_u32 s50, s50, 0x20000
    buffer_load_dwordx4 v12, s[24:27], s50 offen lds
    buffer_load_dwordx4 v13, s[24:27], s50 offen offset:1024 lds
    buffer_load_dwordx4 v14, s[24:27], s50 offen offset:2048 lds
    buffer_load_dwordx4 v15, s[24:27], s50 offen offset:3072 lds
    s_waitcnt vmcnt(16)
    s_barrier
    s_add_u32 m0, s52, 32768
    s_add_u32 s50, s42, 6
    s_and_b32 s50, s50, 7
    s_lshl_b32 s50, s50, 7
    buffer_load_dwordx4 v12, s[24:27], s50 offen lds
    buffer_load_dwordx4 v13, s[24:27], s50 offen offset:1024 lds
    buffer_load_dwordx4 v14, s[24:27], s50 offen offset:2048 lds
    buffer_load_dwordx4 v15, s[24:27], s50 offen offset:3072 lds
    s_add_u32 m0, s52, 49152
    s_add_u32 s50, s50, 0x20000
    buffer_load_dwordx4 v12, s[24:27], s50 offen lds
    buffer_load_dwordx4 v13, s[24:27], s50 offen offset:1024 lds
    buffer_load_dwordx4 v14, s[24:27], s50 offen offset:2048 lds
    buffer_load_dwordx4 v15, s[24:27], s50 offen offset:3072 lds
    s_waitcnt vmcnt(16)
    s_barrier
    s_add_u32 m0, s52, 65536
    s_add_u32 s50, s42, 7
    s_and_b32 s50, s50, 7
    s_lshl_b32 s50, s50, 7
    buffer_load_dwordx4 v12, s[24:27], s50 offen lds
    buffer_load_dwordx4 v13, s[24:27], s50 offen offset:1024 lds
    buffer_load_dwordx4 v14, s[24:27], s50 offen offset:2048 lds
    buffer_load_dwordx4 v15, s[24:27], s50 offen offset:3072 lds
    s_add_u32 m0, s52, 81920
    s_add_u32 s50, s50, 0x20000
    buffer_load_dwordx4 v12, s[24:27], s50 offen lds
    buffer_load_dwordx4 v13, s[24:27], s50 offen offset:1024 lds
    buffer_load_dwordx4 v14, s[24:27], s50 offen offset:2048 lds
    buffer_load_dwordx4 v15, s[24:27], s50 offen offset:3072 lds
    s_waitcnt vmcnt(16)
    s_barrier
    s_waitcnt vmcnt(0)
    s_barrier
    s_and_b32 s47, s7, 1
    s_xor_b32 s47, s47, 1
    s_lshl_b32 s48, s47, 1
    s_add_u32 s48, s48, 28
    s_lshl_b32 s48, 3, s48
    s_lshl_b32 s47, s47, 12
    s_add_u32 s47, s47, 57344
    s_mov_b32 s56, 0
    buffer_load_dword v22, v17, s[28:31], 0 offen sc1
    s_waitcnt vmcnt(0)
    v_cmp_eq_u32 vcc, 1, v22
    s_mov_b32 s49, 0xf
L_poll0:
    s_and_b32 s43, vcc_lo, s49
    s_cmp_eq_u32 s43, s49
    s_cbranch_scc1 L_got0
    buffer_load_dword v22, v17, s[28:31], 0 offen sc1
    s_add_u32 s56, s56, 1
    s_waitcnt vmcnt(0)
    v_cmp_eq_u32 vcc, 1, v22
    s_cmp_lt_u32 s56, 0x40000
    s_cbranch_scc1 L_poll0
L_got0:
    buffer_load_dwordx4 v[160:163], v16, s[28:31], 0 offen sc1
    s_mov_b32 s43, 4096
    buffer_load_dwordx4 v[164:167], v16, s[28:31], s43 offen sc1
    s_mov_b32 s49, 0xf0
L_poll1:
    s_and_b32 s43, vcc_lo, s49
    s_cmp_eq_u32 s43, s49
    s_cbranch_scc1 L_got1
    buffer_load_dword v22, v17, s[28:31], 0 offen sc1
    s_add_u32 s56, s56, 1
    s_waitcnt vmcnt(0)
    v_cmp_eq_u32 vcc, 1, v22
    s_cmp_lt_u32 s56, 0x40000
    s_cbranch_scc1 L_poll1
L_got1:
    s_mov_b32 s43, 8192
    buffer_load_dwordx4 v[168:171], v16, s[28:31], s43 offen sc1
    s_mov_b32 s43, 12288
    buffer_load_dwordx4 v[172:175], v16, s[28:31], s43 offen sc1
    s_mov_b32 s49, 0xf00
    s_barrier
    ds_read_b128 v[220:223], v42
    ds_read_b128 v[224:227], v42 offset:1024
L_poll2:
    s_and_b32 s43, vcc_lo, s49
    s_cmp_eq_u32 s43, s49
    s_cbranch_scc1 L_got2
    buffer_load_dword v22, v17, s[28:31], 0 offen sc1
    s_add_u32 s56, s56, 1
    s_waitcnt vmcnt(0)
    v_cmp_eq_u32 vcc, 1, v22
    s_cmp_lt_u32 s56, 0x40000
    s_cbranch_scc1 L_poll2
L_got2:
    s_mov_b32 s43, 16384
    buffer_load_dwordx4 v[176:179], v16, s[28:31], s43 offen sc1
    s_mov_b32 s43, 20480
    buffer_load_dwordx4 v[180:183], v16, s[28:31], s43 offen sc1
    s_mov_b32 s49, 0xf000
L_poll3:
    s_and_b32 s43, vcc_lo, s49
    s_cmp_eq_u32 s43, s49
    s_cbranch_scc1 L_got3
    buffer_load_dword v22, v17, s[28:31], 0 offen sc1
    s_add_u32 s56, s56, 1
    s_waitcnt vmcnt(0)
    v_cmp_eq_u32 vcc, 1, v22
    s_cmp_lt_u32 s56, 0x40000
    s_cbranch_scc1 L_poll3
L_got3:
    s_mov_b32 s43, 24576
    buffer_load_dwordx4 v[184:187], v16, s[28:31], s43 offen sc1
    s_mov_b32 s43, 28672
    buffer_load_dwordx4 v[188:191], v16, s[28:31], s43 offen sc1
    s_mov_b32 s49, 0xf0000
L_poll4:
    s_and_b32 s43, vcc_lo, s49
    s_cmp_eq_u32 s43, s49
    s_cbranch_scc1 L_got4
    buffer_load_dword v22, v17, s[28:31], 0 offen sc1
    s_add_u32 s56, s56, 1
    s_waitcnt vmcnt(0)
    v_cmp_eq_u32 vcc, 1, v22
    s_cmp_lt_u32 s56, 0x40000
    s_cbranch_scc1 L_poll4
L_got4:
    s_mov_b32 s43, 32768
    buffer_load_dwordx4 v[192:195], v16, s[28:31], s43 offen sc1
    s_mov_b32 s43, 36864
    buffer_load_dwordx4 v[196:199], v16, s[28:31], s43 offen sc1
    s_mov_b32 s49, 0xf00000
L_poll5:
    s_and_b32 s43, vcc_lo, s49
    s_cmp_eq_u32 s43, s49
    s_cbranch_scc1 L_got5
    buffer_load_dword v22, v17, s[28:31], 0 offen sc1
    s_add_u32 s56, s56, 1
    s_waitcnt vmcnt(0)
    v_cmp_eq_u32 vcc, 1, v22
    s_cmp_lt_u32 s56, 0x40000
    s_cbranch_scc1 L_poll5
L_got5:
    s_mov_b32 s43, 40960
    buffer_load_dwordx4 v[200:203], v16, s[28:31], s43 offen sc1
    s_mov_b32 s43, 45056
    buffer_load_dwordx4 v[204:207], v16, s[28:31], s43 offen sc1
    s_mov_b32 s49, 0xf000000
L_poll6:
    s_and_b32 s43, vcc_lo, s49
    s_cmp_eq_u32 s43, s49
    s_cbranch_scc1 L_got6
    buffer_load_dword v22, v17, s[28:31], 0 offen sc1
    s_add_u32 s56, s56, 1
    s_waitcnt vmcnt(0)
    v_cmp_eq_u32 vcc, 1, v22
    s_cmp_lt_u32 s56, 0x40000
    s_cbranch_scc1 L_poll6
L_got6:
    s_mov_b32 s43, 49152
    buffer_load_dwordx4 v[208:211], v16, s[28:31], s43 offen sc1
    s_mov_b32 s43, 53248
    buffer_load_dwordx4 v[212:215], v16, s[28:31], s43 offen sc1
    s_mov_b32 s49, 0x0
    s_or_b32 s49, s49, s48
L_poll7:
    s_and_b32 s43, vcc_lo, s49
    s_cmp_eq_u32 s43, s49
    s_cbranch_scc1 L_got7
    buffer_load_dword v22, v17, s[28:31], 0 offen sc1
    s_add_u32 s56, s56, 1
    s_waitcnt vmcnt(0)
    v_cmp_eq_u32 vcc, 1, v22
    s_cmp_lt_u32 s56, 0x40000
    s_cbranch_scc1 L_poll7
L_got7:
    buffer_load_dwordx4 v[216:219], v16, s[28:31], s47 offen sc1
    s_waitcnt vmcnt(14)
    v_lshlrev_b32 v24, 16, v160
    v_and_b32 v25, 0xffff0000, v160
    v_lshlrev_b32 v26, 16, v161
    v_and_b32 v27, 0xffff0000, v161
    v_lshlrev_b32 v28, 16, v162
    v_and_b32 v29, 0xffff0000, v162
    v_lshlrev_b32 v30, 16, v163
    v_and_b32 v31, 0xffff0000, v163
    s_waitcnt vmcnt(13)
    v_lshlrev_b32 v32, 16, v164
    v_and_b32 v33, 0xffff0000, v164
    v_lshlrev_b32 v34, 16, v165
    v_and_b32 v35, 0xffff0000, v165
    v_lshlrev_b32 v36, 16, v166
    v_and_b32 v37, 0xffff0000, v166
    v_lshlrev_b32 v38, 16, v167
    v_and_b32 v39, 0xffff0000, v167
    v_pk_add_f32 v[24:25], v[24:25], v[32:33]
    v_pk_add_f32 v[26:27], v[26:27], v[34:35]
    v_pk_add_f32 v[28:29], v[28:29], v[36:37]
    v_pk_add_f32 v[30:31], v[30:31], v[38:39]
    s_waitcnt vmcnt(12)
    v_lshlrev_b32 v32, 16, v168
    v_and_b32 v33, 0xffff0000, v168
    v_lshlrev_b32 v34, 16, v169
    v_and_b32 v35, 0xffff0000, v169
    v_lshlrev_b32 v36, 16, v170
    v_and_b32 v37, 0xffff0000, v170
    v_lshlrev_b32 v38, 16, v171
    v_and_b32 v39, 0xffff0000, v171
    v_pk_add_f32 v[24:25], v[24:25], v[32:33]
    v_pk_add_f32 v[26:27], v[26:27], v[34:35]
    v_pk_add_f32 v[28:29], v[28:29], v[36:37]
    v_pk_add_f32 v[30:31], v[30:31], v[38:39]
    s_waitcnt vmcnt(11)
    v_lshlrev_b32 v32, 16, v172
    v_and_b32 v33, 0xffff0000, v172
    v_lshlrev_b32 v34, 16, v173
    v_and_b32 v35, 0xffff0000, v173
    v_lshlrev_b32 v36, 16, v174
    v_and_b32 v37, 0xffff0000, v174
    v_lshlrev_b32 v38, 16, v175
    v_and_b32 v39, 0xffff0000, v175
    v_pk_add_f32 v[24:25], v[24:25], v[32:33]
    v_pk_add_f32 v[26:27], v[26:27], v[34:35]
    v_pk_add_f32 v[28:29], v[28:29], v[36:37]
    v_pk_add_f32 v[30:31], v[30:31], v[38:39]
    s_waitcnt vmcnt(10)
    v_lshlrev_b32 v32, 16, v176
    v_and_b32 v33, 0xffff0000, v176
    v_lshlrev_b32 v34, 16, v177
    v_and_b32 v35, 0xffff0000, v177
    v_lshlrev_b32 v36, 16, v178
    v_and_b32 v37, 0xffff0000, v178
    v_lshlrev_b32 v38, 16, v179
    v_and_b32 v39, 0xffff0000, v179
    v_pk_add_f32 v[24:25], v[24:25], v[32:33]
    v_pk_add_f32 v[26:27], v[26:27], v[34:35]
    v_pk_add_f32 v[28:29], v[28:29], v[36:37]
    v_pk_add_f32 v[30:31], v[30:31], v[38:39]
    s_waitcnt vmcnt(9)
    v_lshlrev_b32 v32, 16, v180
    v_and_b32 v33, 0xffff0000, v180
    v_lshlrev_b32 v34, 16, v181
    v_and_b32 v35, 0xffff0000, v181
    v_lshlrev_b32 v36, 16, v182
    v_and_b32 v37, 0xffff0000, v182
    v_lshlrev_b32 v38, 16, v183
    v_and_b32 v39, 0xffff0000, v183
    v_pk_add_f32 v[24:25], v[24:25], v[32:33]
    v_pk_add_f32 v[26:27], v[26:27], v[34:35]
    v_pk_add_f32 v[28:29], v[28:29], v[36:37]
    v_pk_add_f32 v[30:31], v[30:31], v[38:39]
    s_waitcnt vmcnt(8)
    v_lshlrev_b32 v32, 16, v184
    v_and_b32 v33, 0xffff0000, v184
    v_lshlrev_b32 v34, 16, v185
    v_and_b32 v35, 0xffff0000, v185
    v_lshlrev_b32 v36, 16, v186
    v_and_b32 v37, 0xffff0000, v186
    v_lshlrev_b32 v38, 16, v187
    v_and_b32 v39, 0xffff0000, v187
    v_pk_add_f32 v[24:25], v[24:25], v[32:33]
    v_pk_add_f32 v[26:27], v[26:27], v[34:35]
    v_pk_add_f32 v[28:29], v[28:29], v[36:37]
    v_pk_add_f32 v[30:31], v[30:31], v[38:39]
    s_waitcnt vmcnt(7)
    v_lshlrev_b32 v32, 16, v188
    v_and_b32 v33, 0xffff0000, v188
    v_lshlrev_b32 v34, 16, v189
    v_and_b32 v35, 0xffff0000, v189
    v_lshlrev_b32 v36, 16, v190
    v_and_b32 v37, 0xffff0000, v190
    v_lshlrev_b32 v38, 16, v191
    v_and_b32 v39, 0xffff0000, v191
    v_pk_add_f32 v[24:25], v[24:25], v[32:33]
    v_pk_add_f32 v[26:27], v[26:27], v[34:35]
    s_nop 0
L_mk2:
    s_cbranch_execz L_rt2
    v_pk_add_f32 v[28:29], v[28:29], v[36:37]
    v_pk_add_f32 v[30:31], v[30:31], v[38:39]
    s_waitcnt vmcnt(6)
    v_lshlrev_b32 v32, 16, v192
    v_and_b32 v33, 0xffff0000, v192
    v_lshlrev_b32 v34, 16, v193
    v_and_b32 v35, 0xffff0000, v193
    v_lshlrev_b32 v36, 16, v194
    v_and_b32 v37, 0xffff0000, v194
    v_lshlrev_b32 v38, 16, v195
    v_and_b32 v39, 0xffff0000, v195
    v_pk_add_f32 v[24:25], v[24:25], v[32:33]
    v_pk_add_f32 v[26:27], v[26:27], v[34:35]
    v_pk_add_f32 v[28:29], v[28:29], v[36:37]
    v_pk_add_f32 v[30:31], v[30:31], v[38:39]
    s_waitcnt vmcnt(5)
    v_lshlrev_b32 v32, 16, v196
    v_and_b32 v33, 0xffff0000, v196
    v_lshlrev_b32 v34, 16, v197
    v_and_b32 v35, 0xffff0000, v197
    v_lshlrev_b32 v36, 16, v198
    v_and_b32 v37, 0xffff0000, v198
    v_lshlrev_b32 v38, 16, v199
    v_and_b32 v39, 0xffff0000, v199
    v_pk_add_f32 v[24:25], v[24:25], v[32:33]
    v_pk_add_f32 v[26:27], v[26:27], v[34:35]
    v_pk_add_f32 v[28:29], v[28:29], v[36:37]
    v_pk_add_f32 v[30:31], v[30:31], v[38:39]
    s_waitcnt vmcnt(4)
    v_lshlrev_b32 v32, 16, v200
    v_and_b32 v33, 0xffff0000, v200
    v_lshlrev_b32 v34, 16, v201
    v_and_b32 v35, 0xffff0000, v201
    v_lshlrev_b32 v36, 16, v202
    v_and_b32 v37, 0xffff0000, v202
    v_lshlrev_b32 v38, 16, v203
    v_and_b32 v39, 0xffff0000, v203
    v_pk_add_f32 v[24:25], v[24:25], v[32:33]
    v_pk_add_f32 v[26:27], v[26:27], v[34:35]
    v_pk_add_f32 v[28:29], v[28:29], v[36:37]
    v_pk_add_f32 v[30:31], v[30:31], v[38:39]
    s_waitcnt vmcnt(3)
    v_lshlrev_b32 v32, 16, v204
    v_and_b32 v33, 0xffff0000, v204
    v_lshlrev_b32 v34, 16, v205
    v_and_b32 v35, 0xffff0000, v205
    v_lshlrev_b32 v36, 16, v206
    v_and_b32 v37, 0xffff0000, v206
    v_lshlrev_b32 v38, 16, v207
    v_and_b32 v39, 0xffff0000, v207
    v_pk_add_f32 v[24:25], v[24:25], v[32:33]
    v_pk_add_f32 v[26:27], v[26:27], v[34:35]
    v_pk_add_f32 v[28:29], v[28:29], v[36:37]
    v_pk_add_f32 v[30:31], v[30:31], v[38:39]
    s_waitcnt lgkmcnt(1)
    v_pk_add_f32 v[24:25], v[24:25], v[220:221]
    v_pk_add_f32 v[26:27], v[26:27], v[222:223]
    s_waitcnt lgkmcnt(0)
    v_pk_add_f32 v[28:29], v[28:29], v[224:225]
    v_pk_add_f32 v[30:31], v[30:31], v[226:227]
    s_waitcnt vmcnt(2)
    v_lshlrev_b32 v32, 16, v208
    v_and_b32 v33, 0xffff0000, v208
    v_lshlrev_b32 v34, 16, v209
    v_and_b32 v35, 0xffff0000, v209
    v_lshlrev_b32 v36, 16, v210
    v_and_b32 v37, 0xffff0000, v210
    v_lshlrev_b32 v38, 16, v211
    v_and_b32 v39, 0xffff0000, v211
    v_pk_add_f32 v[24:25], v[24:25], v[32:33]
    v_pk_add_f32 v[26:27], v[26:27], v[34:35]
    v_pk_add_f32 v[28:29], v[28:29], v[36:37]
    v_pk_add_f32 v[30:31], v[30:31], v[38:39]
    s_waitcnt vmcnt(1)
    v_lshlrev_b32 v32, 16, v212
    v_and_b32 v33, 0xffff0000, v212
    v_lshlrev_b32 v34, 16, v213
    v_and_b32 v35, 0xffff0000, v213
    v_lshlrev_b32 v36, 16, v214
    v_and_b32 v37, 0xffff0000, v214
    v_lshlrev_b32 v38, 16, v215
    v_and_b32 v39, 0xffff0000, v215
    v_pk_add_f32 v[24:25], v[24:25], v[32:33]
    v_pk_add_f32 v[26:27], v[26:27], v[34:35]
    v_pk_add_f32 v[28:29], v[28:29], v[36:37]
    v_pk_add_f32 v[30:31], v[30:31], v[38:39]
    s_waitcnt vmcnt(0)
    v_lshlrev_b32 v32, 16, v216
    v_and_b32 v33, 0xffff0000, v216
    v_lshlrev_b32 v34, 16, v217
    v_and_b32 v35, 0xffff0000, v217
    v_lshlrev_b32 v36, 16, v218
    v_and_b32 v37, 0xffff0000, v218
    v_lshlrev_b32 v38, 16, v219
    v_and_b32 v39, 0xffff0000, v219
    v_pk_add_f32 v[24:25], v[24:25], v[32:33]
    v_pk_add_f32 v[26:27], v[26:27], v[34:35]
    v_pk_add_f32 v[28:29], v[28:29], v[36:37]
    v_pk_add_f32 v[30:31], v[30:31], v[38:39]
    v_cvt_pk_bf16_f32 v32, v24, v25
    v_cvt_pk_bf16_f32 v33, v26, v27
    v_cvt_pk_bf16_f32 v34, v28, v29
    v_cvt_pk_bf16_f32 v35, v30, v31
    ds_bpermute_b32 v36, v43, v32
    ds_bpermute_b32 v37, v43, v33
    ds_bpermute_b32 v38, v43, v34
    ds_bpermute_b32 v39, v43, v35
    s_waitcnt lgkmcnt(0)
    buffer_store_dwordx4 v[36:39], v18, s[32:35], 0 offen sc1
    s_endpgm
L_hslow:
    s_barrier
    s_barrier
    s_branch L_hgo
.p2align 12
L_compute:
    s_barrier
    ds_read_b128 v[80:83], v10
    ds_read_b64_tr_b16 v[48:49], v2
    ds_read_b64_tr_b16 v[50:51], v2 offset:2048
    ds_read_b64_tr_b16 v[52:53], v3
    ds_read_b64_tr_b16 v[54:55], v3 offset:2048
    ds_read_b64_tr_b16 v[56:57], v4
    ds_read_b64_tr_b16 v[58:59], v4 offset:2048
    ds_read_b64_tr_b16 v[60:61], v5
    ds_read_b64_tr_b16 v[62:63], v5 offset:2048
    ds_read_b128 v[84:87], v11
    ds_read_b64_tr_b16 v[64:65], v2 offset:8192
    ds_read_b64_tr_b16 v[66:67], v2 offset:10240
    s_waitcnt lgkmcnt(7)
    v_mfma_f32_32x32x16_bf16 v[128:143], v[48:51], v[80:83], 0
    ds_read_b64_tr_b16 v[68:69], v3 offset:8192
    ds_read_b64_tr_b16 v[70:71], v3 offset:10240
    v_mfma_f32_32x32x16_bf16 v[144:159], v[52:55], v[80:83], 0
    ds_read_b64_tr_b16 v[72:73], v4 offset:8192
    ds_read_b64_tr_b16 v[74:75], v4 offset:10240
    s_waitcnt lgkmcnt(7)
    v_mfma_f32_32x32x16_bf16 v[160:175], v[56:59], v[80:83], 0
    ds_read_b64_tr_b16 v[76:77], v5 offset:8192
    ds_read_b64_tr_b16 v[78:79], v5 offset:10240
    v_mfma_f32_32x32x16_bf16 v[176:191], v[60:63], v[80:83], 0
    s_barrier
    ds_read_b128 v[88:91], v12
    ds_read_b64_tr_b16 v[48:49], v2 offset:16384
    ds_read_b64_tr_b16 v[50:51], v2 offset:18432
    s_waitcnt lgkmcnt(7)
    v_mfma_f32_32x32x16_bf16 v[128:143], v[64:67], v[84:87], v[128:143]
    ds_read_b64_tr_b16 v[52:53], v3 offset:16384
    ds_read_b64_tr_b16 v[54:55], v3 offset:18432
    v_mfma_f32_32x32x16_bf16 v[144:159], v[68:71], v[84:87], v[144:159]
    ds_read_b64_tr_b16 v[56:57], v4 offset:16384
    ds_read_b64_tr_b16 v[58:59], v4 offset:18432
    s_waitcnt lgkmcnt(7)
    v_mfma_f32_32x32x16_bf16 v[160:175], v[72:75], v[84:87], v[160:175]
    ds_read_b64_tr_b16 v[60:61], v5 offset:16384
    ds_read_b64_tr_b16 v[62:63], v5 offset:18432
    v_mfma_f32_32x32x16_bf16 v[176:191], v[76:79], v[84:87], v[176:191]
    ds_read_b128 v[80:83], v13
    ds_read_b64_tr_b16 v[64:65], v2 offset:24576
    ds_read_b64_tr_b16 v[66:67], v2 offset:26624
    s_waitcnt lgkmcnt(7)
    v_mfma_f32_32x32x16_bf16 v[128:143], v[48:51], v[88:91], v[128:143]
    ds_read_b64_tr_b16 v[68:69], v3 offset:24576
    ds_read_b64_tr_b16 v[70:71], v3 offset:26624
    s_mov_b64 exec, 0
    s_cmp_eq_u32 s3, 0
    s_cbranch_scc1 L_mk1
L_rt1:
    s_cmp_eq_u32 s3, 1
    s_cbranch_scc1 L_mk2
L_rt2:
    s_cmp_eq_u32 s3, 2
    s_cbranch_scc1 L_mk3
L_rt3:
    s_cmp_eq_u32 s3, 3
    s_cbranch_scc1 L_mk4
L_rt4:
    s_cmp_eq_u32 s3, 0
    s_cbranch_scc1 L_mk5
L_rt5:
    s_cmp_eq_u32 s3, 1
    s_cbranch_scc1 L_mk6
L_rt6:
    s_mov_b64 exec, -1
    v_mfma_f32_32x32x16_bf16 v[144:159], v[52:55], v[88:91], v[144:159]
    ds_read_b64_tr_b16 v[72:73], v4 offset:24576
    ds_read_b64_tr_b16 v[74:75], v4 offset:26624
    s_waitcnt lgkmcnt(7)
    v_mfma_f32_32x32x16_bf16 v[160:175], v[56:59], v[88:91], v[160:175]
    ds_read_b64_tr_b16 v[76:77], v5 offset:24576
    ds_read_b64_tr_b16 v[78:79], v5 offset:26624
    v_mfma_f32_32x32x16_bf16 v[176:191], v[60:63], v[88:91], v[176:191]
    s_barrier
    ds_read_b128 v[84:87], v10 offset:8192
    ds_read_b64_tr_b16 v[48:49], v2 offset:32768
    ds_read_b64_tr_b16 v[50:51], v2 offset:34816
    s_waitcnt lgkmcnt(7)
    v_mfma_f32_32x32x16_bf16 v[128:143], v[64:67], v[80:83], v[128:143]
    ds_read_b64_tr_b16 v[52:53], v3 offset:32768
    ds_read_b64_tr_b16 v[54:55], v3 offset:34816
    v_mfma_f32_32x32x16_bf16 v[144:159], v[68:71], v[80:83], v[144:159]
    ds_read_b64_tr_b16 v[56:57], v4 offset:32768
    ds_read_b64_tr_b16 v[58:59], v4 offset:34816
    s_waitcnt lgkmcnt(7)
    v_mfma_f32_32x32x16_bf16 v[160:175], v[72:75], v[80:83], v[160:175]
    ds_read_b64_tr_b16 v[60:61], v5 offset:32768
    ds_read_b64_tr_b16 v[62:63], v5 offset:34816
    v_mfma_f32_32x32x16_bf16 v[176:191], v[76:79], v[80:83], v[176:191]
    ds_read_b128 v[88:91], v11 offset:8192
    ds_read_b64_tr_b16 v[64:65], v2 offset:40960
    ds_read_b64_tr_b16 v[66:67], v2 offset:43008
    s_waitcnt lgkmcnt(7)
    v_mfma_f32_32x32x16_bf16 v[128:143], v[48:51], v[84:87], v[128:143]
    ds_read_b64_tr_b16 v[68:69], v3 offset:40960
    ds_read_b64_tr_b16 v[70:71], v3 offset:43008
    v_mfma_f32_32x32x16_bf16 v[144:159], v[52:55], v[84:87], v[144:159]
    ds_read_b64_tr_b16 v[72:73], v4 offset:40960
    ds_read_b64_tr_b16 v[74:75], v4 offset:43008
    s_waitcnt lgkmcnt(7)
    v_mfma_f32_32x32x16_bf16 v[160:175], v[56:59], v[84:87], v[160:175]
    ds_read_b64_tr_b16 v[76:77], v5 offset:40960
    ds_read_b64_tr_b16 v[78:79], v5 offset:43008
    v_mfma_f32_32x32x16_bf16 v[176:191], v[60:63], v[84:87], v[176:191]
    s_barrier
    ds_read_b128 v[80:83], v12 offset:8192
    ds_read_b64_tr_b16 v[48:49], v2 offset:49152
    ds_read_b64_tr_b16 v[50:51], v2 offset:51200
    s_waitcnt lgkmcnt(7)
    v_mfma_f32_32x32x16_bf16 v[128:143], v[64:67], v[88:91], v[128:143]
    ds_read_b64_tr_b16 v[52:53], v3 offset:49152
    ds_read_b64_tr_b16 v[54:55], v3 offset:51200
    v_mfma_f32_32x32x16_bf16 v[144:159], v[68:71], v[88:91], v[144:159]
    ds_read_b64_tr_b16 v[56:57], v4 offset:49152
    ds_read_b64_tr_b16 v[58:59], v4 offset:51200
    s_waitcnt lgkmcnt(7)
    v_mfma_f32_32x32x16_bf16 v[160:175], v[72:75], v[88:91], v[160:175]
    ds_read_b64_tr_b16 v[60:61], v5 offset:49152
    ds_read_b64_tr_b16 v[62:63], v5 offset:51200
    v_mfma_f32_32x32x16_bf16 v[176:191], v[76:79], v[88:91], v[176:191]
    ds_read_b128 v[84:87], v13 offset:8192
    ds_read_b64_tr_b16 v[64:65], v2 offset:57344
    ds_read_b64_tr_b16 v[66:67], v2 offset:59392
    s_waitcnt lgkmcnt(7)
    v_mfma_f32_32x32x16_bf16 v[128:143], v[48:51], v[80:83], v[128:143]
    ds_read_b64_tr_b16 v[68:69], v3 offset:57344
    ds_read_b64_tr_b16 v[70:71], v3 offset:59392
    v_mfma_f32_32x32x16_bf16 v[144:159], v[52:55], v[80:83], v[144:159]
    ds_read_b64_tr_b16 v[72:73], v4 offset:57344
    ds_read_b64_tr_b16 v[74:75], v4 offset:59392
    s_waitcnt lgkmcnt(7)
    v_mfma_f32_32x32x16_bf16 v[160:175], v[56:59], v[80:83], v[160:175]
    ds_read_b64_tr_b16 v[76:77], v5 offset:57344
    ds_read_b64_tr_b16 v[78:79], v5 offset:59392
    v_mfma_f32_32x32x16_bf16 v[176:191], v[60:63], v[80:83], v[176:191]
    s_barrier
    ds_read_b128 v[88:91], v10 offset:32768
    ds_read_b64_tr_b16 v[48:49], v6
    ds_read_b64_tr_b16 v[50:51], v6 offset:2048
    s_waitcnt lgkmcnt(7)
    v_mfma_f32_32x32x16_bf16 v[128:143], v[64:67], v[84:87], v[128:143]
    ds_read_b64_tr_b16 v[52:53], v7
    ds_read_b64_tr_b16 v[54:55], v7 offset:2048
    v_mfma_f32_32x32x16_bf16 v[144:159], v[68:71], v[84:87], v[144:159]
    ds_read_b64_tr_b16 v[56:57], v8
    ds_read_b64_tr_b16 v[58:59], v8 offset:2048
    s_waitcnt lgkmcnt(7)
    v_mfma_f32_32x32x16_bf16 v[160:175], v[72:75], v[84:87], v[160:175]
    ds_read_b64_tr_b16 v[60:61], v9
    ds_read_b64_tr_b16 v[62:63], v9 offset:2048
    v_mfma_f32_32x32x16_bf16 v[176:191], v[76:79], v[84:87], v[176:191]
    ds_read_b128 v[80:83], v11 offset:32768
    ds_read_b64_tr_b16 v[64:65], v6 offset:8192
    ds_read_b64_tr_b16 v[66:67], v6 offset:10240
    s_waitcnt lgkmcnt(7)
    v_mfma_f32_32x32x16_bf16 v[128:143], v[48:51], v[88:91], v[128:143]
    ds_read_b64_tr_b16 v[68:69], v7 offset:8192
    ds_read_b64_tr_b16 v[70:71], v7 offset:10240
    v_mfma_f32_32x32x16_bf16 v[144:159], v[52:55], v[88:91], v[144:159]
    ds_read_b64_tr_b16 v[72:73], v8 offset:8192
    ds_read_b64_tr_b16 v[74:75], v8 offset:10240
    s_waitcnt lgkmcnt(7)
    v_mfma_f32_32x32x16_bf16 v[160:175], v[56:59], v[88:91], v[160:175]
    ds_read_b64_tr_b16 v[76:77], v9 offset:8192
    ds_read_b64_tr_b16 v[78:79], v9 offset:10240
    v_mfma_f32_32x32x16_bf16 v[176:191], v[60:63], v[88:91], v[176:191]
    s_barrier
    ds_read_b128 v[84:87], v12 offset:32768
    ds_read_b64_tr_b16 v[48:49], v6 offset:16384
    ds_read_b64_tr_b16 v[50:51], v6 offset:18432
    s_waitcnt lgkmcnt(7)
    v_mfma_f32_32x32x16_bf16 v[128:143], v[64:67], v[80:83], v[128:143]
    ds_read_b64_tr_b16 v[52:53], v7 offset:16384
    ds_read_b64_tr_b16 v[54:55], v7 offset:18432
    v_mfma_f32_32x32x16_bf16 v[144:159], v[68:71], v[80:83], v[144:159]
    ds_read_b64_tr_b16 v[56:57], v8 offset:16384
    ds_read_b64_tr_b16 v[58:59], v8 offset:18432
    s_waitcnt lgkmcnt(7)
    v_mfma_f32_32x32x16_bf16 v[160:175], v[72:75], v[80:83], v[160:175]
    ds_read_b64_tr_b16 v[60:61], v9 offset:16384
    ds_read_b64_tr_b16 v[62:63], v9 offset:18432
    v_mfma_f32_32x32x16_bf16 v[176:191], v[76:79], v[80:83], v[176:191]
    ds_read_b128 v[88:91], v13 offset:32768
    ds_read_b64_tr_b16 v[64:65], v6 offset:24576
    ds_read_b64_tr_b16 v[66:67], v6 offset:26624
    s_waitcnt lgkmcnt(7)
    v_mfma_f32_32x32x16_bf16 v[128:143], v[48:51], v[84:87], v[128:143]
    ds_read_b64_tr_b16 v[68:69], v7 offset:24576
    ds_read_b64_tr_b16 v[70:71], v7 offset:26624
    v_mfma_f32_32x32x16_bf16 v[144:159], v[52:55], v[84:87], v[144:159]
    ds_read_b64_tr_b16 v[72:73], v8 offset:24576
    ds_read_b64_tr_b16 v[74:75], v8 offset:26624
    s_cmp_lg_u32 s100, 0
    s_cbranch_scc1 L_w0_arr
    s_waitcnt vmcnt(0)
    buffer_store_dword v240, v241, s[36:39], 0 offen sc1
L_w0_arr:
    s_waitcnt lgkmcnt(7)
    v_mfma_f32_32x32x16_bf16 v[160:175], v[56:59], v[84:87], v[160:175]
    ds_read_b64_tr_b16 v[76:77], v9 offset:24576
    ds_read_b64_tr_b16 v[78:79], v9 offset:26624
    v_mfma_f32_32x32x16_bf16 v[176:191], v[60:63], v[84:87], v[176:191]
    s_barrier
    ds_read_b128 v[80:83], v10 offset:16384
    ds_read_b64_tr_b16 v[48:49], v2
    ds_read_b64_tr_b16 v[50:51], v2 offset:2048
    s_waitcnt lgkmcnt(7)
    v_mfma_f32_32x32x16_bf16 v[128:143], v[64:67], v[88:91], v[128:143]
    ds_read_b64_tr_b16 v[52:53], v3
    ds_read_b64_tr_b16 v[54:55], v3 offset:2048
    v_mfma_f32_32x32x16_bf16 v[144:159], v[68:71], v[88:91], v[144:159]
    ds_read_b64_tr_b16 v[56:57], v4
    ds_read_b64_tr_b16 v[58:59], v4 offset:2048
    s_waitcnt lgkmcnt(7)
    v_mfma_f32_32x32x16_bf16 v[160:175], v[72:75], v[88:91], v[160:175]
    ds_read_b64_tr_b16 v[60:61], v5
    ds_read_b64_tr_b16 v[62:63], v5 offset:2048
    v_mfma_f32_32x32x16_bf16 v[176:191], v[76:79], v[88:91], v[176:191]
    ds_read_b128 v[84:87], v11 offset:16384
    ds_read_b64_tr_b16 v[64:65], v2 offset:8192
    ds_read_b64_tr_b16 v[66:67], v2 offset:10240
    s_waitcnt lgkmcnt(7)
    v_mfma_f32_32x32x16_bf16 v[128:143], v[48:51], v[80:83], v[128:143]
    ds_read_b64_tr_b16 v[68:69], v3 offset:8192
    ds_read_b64_tr_b16 v[70:71], v3 offset:10240
    v_mfma_f32_32x32x16_bf16 v[144:159], v[52:55], v[80:83], v[144:159]
    ds_read_b64_tr_b16 v[72:73], v4 offset:8192
    ds_read_b64_tr_b16 v[74:75], v4 offset:10240
    s_waitcnt lgkmcnt(7)
    v_mfma_f32_32x32x16_bf16 v[160:175], v[56:59], v[80:83], v[160:175]
    ds_read_b64_tr_b16 v[76:77], v5 offset:8192
    ds_read_b64_tr_b16 v[78:79], v5 offset:10240
    v_mfma_f32_32x32x16_bf16 v[176:191], v[60:63], v[80:83], v[176:191]
    s_barrier
    ds_read_b128 v[88:91], v12 offset:16384
    ds_read_b64_tr_b16 v[48:49], v2 offset:16384
    ds_read_b64_tr_b16 v[50:51], v2 offset:18432
    s_waitcnt lgkmcnt(7)
    v_mfma_f32_32x32x16_bf16 v[128:143], v[64:67], v[84:87], v[128:143]
    ds_read_b64_tr_b16 v[52:53], v3 offset:16384
    ds_read_b64_tr_b16 v[54:55], v3 offset:18432
    v_mfma_f32_32x32x16_bf16 v[144:159], v[68:71], v[84:87], v[144:159]
    ds_read_b64_tr_b16 v[56:57], v4 offset:16384
    ds_read_b64_tr_b16 v[58:59], v4 offset:18432
    s_waitcnt lgkmcnt(7)
    v_mfma_f32_32x32x16_bf16 v[160:175], v[72:75], v[84:87], v[160:175]
    ds_read_b64_tr_b16 v[60:61], v5 offset:16384
    ds_read_b64_tr_b16 v[62:63], v5 offset:18432
    v_mfma_f32_32x32x16_bf16 v[176:191], v[76:79], v[84:87], v[176:191]
    ds_read_b128 v[80:83], v13 offset:16384
    ds_read_b64_tr_b16 v[64:65], v2 offset:24576
    ds_read_b64_tr_b16 v[66:67], v2 offset:26624
    s_waitcnt lgkmcnt(7)
    v_mfma_f32_32x32x16_bf16 v[128:143], v[48:51], v[88:91], v[128:143]
    ds_read_b64_tr_b16 v[68:69], v3 offset:24576
    ds_read_b64_tr_b16 v[70:71], v3 offset:26624
    v_mfma_f32_32x32x16_bf16 v[144:159], v[52:55], v[88:91], v[144:159]
    ds_read_b64_tr_b16 v[72:73], v4 offset:24576
    ds_read_b64_tr_b16 v[74:75], v4 offset:26624
    s_waitcnt lgkmcnt(7)
    v_mfma_f32_32x32x16_bf16 v[160:175], v[56:59], v[88:91], v[160:175]
    ds_read_b64_tr_b16 v[76:77], v5 offset:24576
    ds_read_b64_tr_b16 v[78:79], v5 offset:26624
    v_mfma_f32_32x32x16_bf16 v[176:191], v[60:63], v[88:91], v[176:191]
    s_barrier
    ds_read_b128 v[84:87], v10 offset:40960
    ds_read_b64_tr_b16 v[48:49], v2 offset:32768
    ds_read_b64_tr_b16 v[50:51], v2 offset:34816
    s_waitcnt lgkmcnt(7)
    v_mfma_f32_32x32x16_bf16 v[128:143], v[64:67], v[80:83], v[128:143]
    ds_read_b64_tr_b16 v[52:53], v3 offset:32768
    ds_read_b64_tr_b16 v[54:55], v3 offset:34816
    v_mfma_f32_32x32x16_bf16 v[144:159], v[68:71], v[80:83], v[144:159]
    ds_read_b64_tr_b16 v[56:57], v4 offset:32768
    ds_read_b64_tr_b16 v[58:59], v4 offset:34816
    s_waitcnt lgkmcnt(7)
    v_mfma_f32_32x32x16_bf16 v[160:175], v[72:75], v[80:83], v[160:175]
    ds_read_b64_tr_b16 v[60:61], v5 offset:32768
    ds_read_b64_tr_b16 v[62:63], v5 offset:34816
    v_mfma_f32_32x32x16_bf16 v[176:191], v[76:79], v[80:83], v[176:191]
    ds_read_b128 v[88:91], v11 offset:40960
    ds_read_b64_tr_b16 v[64:65], v2 offset:40960
    ds_read_b64_tr_b16 v[66:67], v2 offset:43008
    s_waitcnt lgkmcnt(7)
    v_mfma_f32_32x32x16_bf16 v[128:143], v[48:51], v[84:87], v[128:143]
    ds_read_b64_tr_b16 v[68:69], v3 offset:40960
    ds_read_b64_tr_b16 v[70:71], v3 offset:43008
    v_mfma_f32_32x32x16_bf16 v[144:159], v[52:55], v[84:87], v[144:159]
    ds_read_b64_tr_b16 v[72:73], v4 offset:40960
    ds_read_b64_tr_b16 v[74:75], v4 offset:43008
    s_waitcnt lgkmcnt(7)
    v_mfma_f32_32x32x16_bf16 v[160:175], v[56:59], v[84:87], v[160:175]
    ds_read_b64_tr_b16 v[76:77], v5 offset:40960
    ds_read_b64_tr_b16 v[78:79], v5 offset:43008
    v_mfma_f32_32x32x16_bf16 v[176:191], v[60:63], v[84:87], v[176:191]
    s_barrier
    ds_read_b128 v[80:83], v12 offset:40960
    ds_read_b64_tr_b16 v[48:49], v2 offset:49152
    ds_read_b64_tr_b16 v[50:51], v2 offset:51200
    s_waitcnt lgkmcnt(7)
    v_mfma_f32_32x32x16_bf16 v[128:143], v[64:67], v[88:91], v[128:143]
    ds_read_b64_tr_b16 v[52:53], v3 offset:49152
    ds_read_b64_tr_b16 v[54:55], v3 offset:51200
    v_mfma_f32_32x32x16_bf16 v[144:159], v[68:71], v[88:91], v[144:159]
    ds_read_b64_tr_b16 v[56:57], v4 offset:49152
    ds_read_b64_tr_b16 v[58:59], v4 offset:51200
    s_waitcnt lgkmcnt(7)
    v_mfma_f32_32x32x16_bf16 v[160:175], v[72:75], v[88:91], v[160:175]
    ds_read_b64_tr_b16 v[60:61], v5 offset:49152
    ds_read_b64_tr_b16 v[62:63], v5 offset:51200
    v_mfma_f32_32x32x16_bf16 v[176:191], v[76:79], v[88:91], v[176:191]
    ds_read_b128 v[84:87], v13 offset:40960
    ds_read_b64_tr_b16 v[64:65], v2 offset:57344
    ds_read_b64_tr_b16 v[66:67], v2 offset:59392
    s_waitcnt lgkmcnt(7)
    v_mfma_f32_32x32x16_bf16 v[128:143], v[48:51], v[80:83], v[128:143]
    ds_read_b64_tr_b16 v[68:69], v3 offset:57344
    ds_read_b64_tr_b16 v[70:71], v3 offset:59392
    v_mfma_f32_32x32x16_bf16 v[144:159], v[52:55], v[80:83], v[144:159]
    ds_read_b64_tr_b16 v[72:73], v4 offset:57344
    ds_read_b64_tr_b16 v[74:75], v4 offset:59392
    s_waitcnt lgkmcnt(7)
    v_mfma_f32_32x32x16_bf16 v[160:175], v[56:59], v[80:83], v[160:175]
    ds_read_b64_tr_b16 v[76:77], v5 offset:57344
    ds_read_b64_tr_b16 v[78:79], v5 offset:59392
    v_mfma_f32_32x32x16_bf16 v[176:191], v[60:63], v[80:83], v[176:191]
    s_barrier
    ds_read_b128 v[88:91], v10 offset:24576
    ds_read_b64_tr_b16 v[48:49], v6
    ds_read_b64_tr_b16 v[50:51], v6 offset:2048
    s_waitcnt lgkmcnt(7)
    v_mfma_f32_32x32x16_bf16 v[128:143], v[64:67], v[84:87], v[128:143]
    ds_read_b64_tr_b16 v[52:53], v7
    ds_read_b64_tr_b16 v[54:55], v7 offset:2048
    v_mfma_f32_32x32x16_bf16 v[144:159], v[68:71], v[84:87], v[144:159]
    ds_read_b64_tr_b16 v[56:57], v8
    ds_read_b64_tr_b16 v[58:59], v8 offset:2048
    s_waitcnt lgkmcnt(7)
    v_mfma_f32_32x32x16_bf16 v[160:175], v[72:75], v[84:87], v[160:175]
    ds_read_b64_tr_b16 v[60:61], v9
    ds_read_b64_tr_b16 v[62:63], v9 offset:2048
    v_mfma_f32_32x32x16_bf16 v[176:191], v[76:79], v[84:87], v[176:191]
    ds_read_b128 v[80:83], v11 offset:24576
    ds_read_b64_tr_b16 v[64:65], v6 offset:8192
    ds_read_b64_tr_b16 v[66:67], v6 offset:10240
    s_waitcnt lgkmcnt(7)
    v_mfma_f32_32x32x16_bf16 v[128:143], v[48:51], v[88:91], v[128:143]
    ds_read_b64_tr_b16 v[68:69], v7 offset:8192
    ds_read_b64_tr_b16 v[70:71], v7 offset:10240
    v_mfma_f32_32x32x16_bf16 v[144:159], v[52:55], v[88:91], v[144:159]
    ds_read_b64_tr_b16 v[72:73], v8 offset:8192
    ds_read_b64_tr_b16 v[74:75], v8 offset:10240
    s_waitcnt lgkmcnt(7)
    v_mfma_f32_32x32x16_bf16 v[160:175], v[56:59], v[88:91], v[160:175]
    ds_read_b64_tr_b16 v[76:77], v9 offset:8192
    ds_read_b64_tr_b16 v[78:79], v9 offset:10240
    v_mfma_f32_32x32x16_bf16 v[176:191], v[60:63], v[88:91], v[176:191]
    s_barrier
    ds_read_b128 v[84:87], v12 offset:24576
    ds_read_b64_tr_b16 v[48:49], v6 offset:16384
    ds_read_b64_tr_b16 v[50:51], v6 offset:18432
    s_waitcnt lgkmcnt(7)
    v_mfma_f32_32x32x16_bf16 v[128:143], v[64:67], v[80:83], v[128:143]
    ds_read_b64_tr_b16 v[52:53], v7 offset:16384
    ds_read_b64_tr_b16 v[54:55], v7 offset:18432
    v_mfma_f32_32x32x16_bf16 v[144:159], v[68:71], v[80:83], v[144:159]
    ds_read_b64_tr_b16 v[56:57], v8 offset:16384
    ds_read_b64_tr_b16 v[58:59], v8 offset:18432
    s_waitcnt lgkmcnt(7)
    v_mfma_f32_32x32x16_bf16 v[160:175], v[72:75], v[80:83], v[160:175]
    ds_read_b64_tr_b16 v[60:61], v9 offset:16384
    ds_read_b64_tr_b16 v[62:63], v9 offset:18432
    v_mfma_f32_32x32x16_bf16 v[176:191], v[76:79], v[80:83], v[176:191]
    ds_read_b128 v[88:91], v13 offset:24576
    ds_read_b64_tr_b16 v[64:65], v6 offset:24576
    ds_read_b64_tr_b16 v[66:67], v6 offset:26624
    s_waitcnt lgkmcnt(7)
    v_mfma_f32_32x32x16_bf16 v[128:143], v[48:51], v[84:87], v[128:143]
    ds_read_b64_tr_b16 v[68:69], v7 offset:24576
    ds_read_b64_tr_b16 v[70:71], v7 offset:26624
    v_mfma_f32_32x32x16_bf16 v[144:159], v[52:55], v[84:87], v[144:159]
    ds_read_b64_tr_b16 v[72:73], v8 offset:24576
    ds_read_b64_tr_b16 v[74:75], v8 offset:26624
    s_waitcnt lgkmcnt(7)
    v_mfma_f32_32x32x16_bf16 v[160:175], v[56:59], v[84:87], v[160:175]
    ds_read_b64_tr_b16 v[76:77], v9 offset:24576
    ds_read_b64_tr_b16 v[78:79], v9 offset:26624
    v_mfma_f32_32x32x16_bf16 v[176:191], v[60:63], v[84:87], v[176:191]
    s_barrier
    ds_read_b128 v[80:83], v10 offset:49152
    ds_read_b64_tr_b16 v[48:49], v2
    ds_read_b64_tr_b16 v[50:51], v2 offset:2048
    s_waitcnt lgkmcnt(7)
    v_mfma_f32_32x32x16_bf16 v[128:143], v[64:67], v[88:91], v[128:143]
    ds_read_b64_tr_b16 v[52:53], v3
    ds_read_b64_tr_b16 v[54:55], v3 offset:2048
    v_mfma_f32_32x32x16_bf16 v[144:159], v[68:71], v[88:91], v[144:159]
    ds_read_b64_tr_b16 v[56:57], v4
    ds_read_b64_tr_b16 v[58:59], v4 offset:2048
    s_waitcnt lgkmcnt(7)
    v_mfma_f32_32x32x16_bf16 v[160:175], v[72:75], v[88:91], v[160:175]
    ds_read_b64_tr_b16 v[60:61], v5
    ds_read_b64_tr_b16 v[62:63], v5 offset:2048
    v_mfma_f32_32x32x16_bf16 v[176:191], v[76:79], v[88:91], v[176:191]
    ds_read_b128 v[84:87], v11 offset:49152
    ds_read_b64_tr_b16 v[64:65], v2 offset:8192
    ds_read_b64_tr_b16 v[66:67], v2 offset:10240
    s_waitcnt lgkmcnt(7)
    v_mfma_f32_32x32x16_bf16 v[128:143], v[48:51], v[80:83], v[128:143]
    ds_read_b64_tr_b16 v[68:69], v3 offset:8192
    ds_read_b64_tr_b16 v[70:71], v3 offset:10240
    v_mfma_f32_32x32x16_bf16 v[144:159], v[52:55], v[80:83], v[144:159]
    ds_read_b64_tr_b16 v[72:73], v4 offset:8192
    ds_read_b64_tr_b16 v[74:75], v4 offset:10240
    s_waitcnt lgkmcnt(7)
    v_mfma_f32_32x32x16_bf16 v[160:175], v[56:59], v[80:83], v[160:175]
    ds_read_b64_tr_b16 v[76:77], v5 offset:8192
    ds_read_b64_tr_b16 v[78:79], v5 offset:10240
    v_mfma_f32_32x32x16_bf16 v[176:191], v[60:63], v[80:83], v[176:191]
    s_barrier
    ds_read_b128 v[88:91], v12 offset:49152
    ds_read_b64_tr_b16 v[48:49], v2 offset:16384
    ds_read_b64_tr_b16 v[50:51], v2 offset:18432
    s_waitcnt lgkmcnt(7)
    v_mfma_f32_32x32x16_bf16 v[128:143], v[64:67], v[84:87], v[128:143]
    ds_read_b64_tr_b16 v[52:53], v3 offset:16384
    ds_read_b64_tr_b16 v[54:55], v3 offset:18432
    v_mfma_f32_32x32x16_bf16 v[144:159], v[68:71], v[84:87], v[144:159]
    ds_read_b64_tr_b16 v[56:57], v4 offset:16384
    ds_read_b64_tr_b16 v[58:59], v4 offset:18432
    s_waitcnt lgkmcnt(7)
    v_mfma_f32_32x32x16_bf16 v[160:175], v[72:75], v[84:87], v[160:175]
    ds_read_b64_tr_b16 v[60:61], v5 offset:16384
    ds_read_b64_tr_b16 v[62:63], v5 offset:18432
    v_mfma_f32_32x32x16_bf16 v[176:191], v[76:79], v[84:87], v[176:191]
    ds_read_b128 v[80:83], v13 offset:49152
    ds_read_b64_tr_b16 v[64:65], v2 offset:24576
    ds_read_b64_tr_b16 v[66:67], v2 offset:26624
    s_waitcnt lgkmcnt(7)
    v_mfma_f32_32x32x16_bf16 v[128:143], v[48:51], v[88:91], v[128:143]
    ds_read_b64_tr_b16 v[68:69], v3 offset:24576
    ds_read_b64_tr_b16 v[70:71], v3 offset:26624
    v_mfma_f32_32x32x16_bf16 v[144:159], v[52:55], v[88:91], v[144:159]
    ds_read_b64_tr_b16 v[72:73], v4 offset:24576
    ds_read_b64_tr_b16 v[74:75], v4 offset:26624
    s_waitcnt lgkmcnt(7)
    v_mfma_f32_32x32x16_bf16 v[160:175], v[56:59], v[88:91], v[160:175]
    ds_read_b64_tr_b16 v[76:77], v5 offset:24576
    ds_read_b64_tr_b16 v[78:79], v5 offset:26624
    v_mfma_f32_32x32x16_bf16 v[176:191], v[60:63], v[88:91], v[176:191]
    s_barrier
    ds_read_b128 v[84:87], v10 offset:57344
    ds_read_b64_tr_b16 v[48:49], v2 offset:32768
    ds_read_b64_tr_b16 v[50:51], v2 offset:34816
    s_waitcnt lgkmcnt(7)
    v_mfma_f32_32x32x16_bf16 v[128:143], v[64:67], v[80:83], v[128:143]
    ds_read_b64_tr_b16 v[52:53], v3 offset:32768
    ds_read_b64_tr_b16 v[54:55], v3 offset:34816
    v_mfma_f32_32x32x16_bf16 v[144:159], v[68:71], v[80:83], v[144:159]
    ds_read_b64_tr_b16 v[56:57], v4 offset:32768
    ds_read_b64_tr_b16 v[58:59], v4 offset:34816
    s_waitcnt lgkmcnt(7)
    v_mfma_f32_32x32x16_bf16 v[160:175], v[72:75], v[80:83], v[160:175]
    ds_read_b64_tr_b16 v[60:61], v5 offset:32768
    ds_read_b64_tr_b16 v[62:63], v5 offset:34816
    v_mfma_f32_32x32x16_bf16 v[176:191], v[76:79], v[80:83], v[176:191]
    ds_read_b128 v[88:91], v11 offset:57344
    ds_read_b64_tr_b16 v[64:65], v2 offset:40960
    ds_read_b64_tr_b16 v[66:67], v2 offset:43008
    s_waitcnt lgkmcnt(7)
    v_mfma_f32_32x32x16_bf16 v[128:143], v[48:51], v[84:87], v[128:143]
    ds_read_b64_tr_b16 v[68:69], v3 offset:40960
    ds_read_b64_tr_b16 v[70:71], v3 offset:43008
    v_mfma_f32_32x32x16_bf16 v[144:159], v[52:55], v[84:87], v[144:159]
    ds_read_b64_tr_b16 v[72:73], v4 offset:40960
    ds_read_b64_tr_b16 v[74:75], v4 offset:43008
    s_waitcnt lgkmcnt(7)
    v_mfma_f32_32x32x16_bf16 v[160:175], v[56:59], v[84:87], v[160:175]
    ds_read_b64_tr_b16 v[76:77], v5 offset:40960
    ds_read_b64_tr_b16 v[78:79], v5 offset:43008
    v_mfma_f32_32x32x16_bf16 v[176:191], v[60:63], v[84:87], v[176:191]
    s_barrier
    ds_read_b128 v[80:83], v12 offset:57344
    ds_read_b64_tr_b16 v[48:49], v2 offset:49152
    ds_read_b64_tr_b16 v[50:51], v2 offset:51200
    s_waitcnt lgkmcnt(7)
    v_mfma_f32_32x32x16_bf16 v[128:143], v[64:67], v[88:91], v[128:143]
    ds_read_b128 v[84:87], v13 offset:57344
    ds_read_b64_tr_b16 v[52:53], v2 offset:57344
    ds_read_b64_tr_b16 v[54:55], v2 offset:59392
    v_mfma_f32_32x32x16_bf16 v[144:159], v[68:71], v[88:91], v[144:159]
    ds_read_b64_tr_b16 v[56:57], v3 offset:49152
    ds_read_b64_tr_b16 v[58:59], v3 offset:51200
    s_waitcnt lgkmcnt(8)
    v_mfma_f32_32x32x16_bf16 v[160:175], v[72:75], v[88:91], v[160:175]
    ds_read_b64_tr_b16 v[60:61], v3 offset:57344
    ds_read_b64_tr_b16 v[62:63], v3 offset:59392
    v_mfma_f32_32x32x16_bf16 v[176:191], v[76:79], v[88:91], v[176:191]
    ds_read_b64_tr_b16 v[64:65], v4 offset:49152
    ds_read_b64_tr_b16 v[66:67], v4 offset:51200
    s_waitcnt lgkmcnt(6)
    v_mfma_f32_32x32x16_bf16 v[128:143], v[48:51], v[80:83], v[128:143]
    ds_read_b64_tr_b16 v[68:69], v4 offset:57344
    ds_read_b64_tr_b16 v[70:71], v4 offset:59392
    v_mfma_f32_32x32x16_bf16 v[128:143], v[52:55], v[84:87], v[128:143]
    ds_read_b64_tr_b16 v[72:73], v5 offset:49152
    ds_read_b64_tr_b16 v[74:75], v5 offset:51200
    s_waitcnt lgkmcnt(6)
    v_mfma_f32_32x32x16_bf16 v[144:159], v[56:59], v[80:83], v[144:159]
    ds_read_b64_tr_b16 v[76:77], v5 offset:57344
    ds_read_b64_tr_b16 v[78:79], v5 offset:59392
    v_mfma_f32_32x32x16_bf16 v[144:159], v[60:63], v[84:87], v[144:159]
    s_waitcnt lgkmcnt(4)
    v_mfma_f32_32x32x16_bf16 v[160:175], v[64:67], v[80:83], v[160:175]
    s_nop 2
    v_mul_f32 v128, s54, v128
    v_mul_f32 v129, s54, v129
    v_mul_f32 v130, s54, v130
    v_mul_f32 v131, s54, v131
    v_mul_f32 v132, s54, v132
    v_mfma_f32_32x32x16_bf16 v[160:175], v[68:71], v[84:87], v[160:175]
    v_mul_f32 v133, s54, v133
    v_mul_f32 v134, s54, v134
    v_mul_f32 v135, s54, v135
    v_mul_f32 v136, s54, v136
    v_mul_f32 v137, s54, v137
    v_mul_f32 v138, s54, v138
    s_waitcnt lgkmcnt(0)
    v_mfma_f32_32x32x16_bf16 v[176:191], v[72:75], v[80:83], v[176:191]
    v_mul_f32 v139, s54, v139
    v_mul_f32 v140, s54, v140
    v_mul_f32 v141, s54, v141
    v_mul_f32 v142, s54, v142
    v_mul_f32 v143, s54, v143
    v_cvt_pk_bf16_f32 v92, v128, v129
    v_mfma_f32_32x32x16_bf16 v[176:191], v[76:79], v[84:87], v[176:191]
    v_cvt_pk_bf16_f32 v93, v130, v131
    v_cvt_pk_bf16_f32 v94, v132, v133
    v_cvt_pk_bf16_f32 v95, v134, v135
    v_cvt_pk_bf16_f32 v96, v136, v137
    v_cvt_pk_bf16_f32 v97, v138, v139
    v_cvt_pk_bf16_f32 v98, v140, v141
    v_cvt_pk_bf16_f32 v99, v142, v143
    s_barrier
    ds_read_b128 v[48:51], v14
    ds_read_b128 v[52:55], v15
    ds_read_b128 v[56:59], v16
    ds_read_b128 v[60:63], v17
    ds_read_b128 v[64:67], v18
    ds_read_b128 v[68:71], v19
    ds_read_b128 v[72:75], v20
    v_pk_mul_f32 v[144:145], v[144:145], s[54:55]
    v_pk_mul_f32 v[146:147], v[146:147], s[54:55]
    v_pk_mul_f32 v[148:149], v[148:149], s[54:55]
    v_pk_mul_f32 v[150:151], v[150:151], s[54:55]
    v_pk_mul_f32 v[152:153], v[152:153], s[54:55]
    v_pk_mul_f32 v[154:155], v[154:155], s[54:55]
    v_pk_mul_f32 v[156:157], v[156:157], s[54:55]
    v_pk_mul_f32 v[158:159], v[158:159], s[54:55]
    v_cvt_pk_bf16_f32 v100, v144, v145
    v_cvt_pk_bf16_f32 v101, v146, v147
    v_cvt_pk_bf16_f32 v102, v148, v149
    v_cvt_pk_bf16_f32 v103, v150, v151
    v_cvt_pk_bf16_f32 v104, v152, v153
    v_cvt_pk_bf16_f32 v105, v154, v155
    v_cvt_pk_bf16_f32 v106, v156, v157
    v_cvt_pk_bf16_f32 v107, v158, v159
    s_waitcnt lgkmcnt(3)
    v_mfma_f32_32x32x16_bf16 v[192:207], v[48:51], v[92:95], 0
    ds_read_b128 v[76:79], v21
    v_mul_f32 v160, s54, v160
    v_mul_f32 v161, s54, v161
    v_mul_f32 v162, s54, v162
    v_mul_f32 v163, s54, v163
    v_mul_f32 v164, s54, v164
    v_mul_f32 v165, s54, v165
    v_mul_f32 v166, s54, v166
    s_nop 0
L_mk3:
    s_cbranch_execz L_rt3
    v_mfma_f32_32x32x16_bf16 v[192:207], v[52:55], v[96:99], v[192:207]
    s_barrier
    ds_read_b128 v[48:51], v14 offset:8192
    v_mul_f32 v167, s54, v167
    v_mul_f32 v168, s54, v168
    v_mul_f32 v169, s54, v169
    v_mul_f32 v170, s54, v170
    v_mul_f32 v171, s54, v171
    v_mul_f32 v172, s54, v172
    v_mul_f32 v173, s54, v173
    v_mfma_f32_32x32x16_bf16 v[192:207], v[56:59], v[100:103], v[192:207]
    ds_read_b128 v[52:55], v15 offset:8192
    v_mul_f32 v174, s54, v174
    v_mul_f32 v175, s54, v175
    v_cvt_pk_bf16_f32 v108, v160, v161
    v_cvt_pk_bf16_f32 v109, v162, v163
    v_cvt_pk_bf16_f32 v110, v164, v165
    v_cvt_pk_bf16_f32 v111, v166, v167
    v_cvt_pk_bf16_f32 v112, v168, v169
    v_mfma_f32_32x32x16_bf16 v[192:207], v[60:63], v[104:107], v[192:207]
    ds_read_b128 v[56:59], v16 offset:8192
    v_cvt_pk_bf16_f32 v113, v170, v171
    v_cvt_pk_bf16_f32 v114, v172, v173
    v_cvt_pk_bf16_f32 v115, v174, v175
    v_mul_f32 v176, s54, v176
    v_mul_f32 v177, s54, v177
    v_mul_f32 v178, s54, v178
    v_mul_f32 v179, s54, v179
    s_waitcnt lgkmcnt(3)
    v_mfma_f32_32x32x16_bf16 v[192:207], v[64:67], v[108:111], v[192:207]
    ds_read_b128 v[60:63], v17 offset:8192
    v_mul_f32 v180, s54, v180
    v_mul_f32 v181, s54, v181
    v_mul_f32 v182, s54, v182
    v_mul_f32 v183, s54, v183
    v_mul_f32 v188, s54, v188
    v_mul_f32 v189, s54, v189
    v_mul_f32 v190, s54, v190
    v_mul_f32 v191, s54, v191
    v_cvt_pk_bf16_f32 v116, v176, v177
    v_cvt_pk_bf16_f32 v117, v178, v179
    v_mfma_f32_32x32x16_bf16 v[192:207], v[68:71], v[112:115], v[192:207]
    ds_read_b128 v[64:67], v18 offset:8192
    v_mul_f32 v184, s54, v184
    v_mul_f32 v185, s54, v185
    v_mul_f32 v186, s54, v186
    v_mul_f32 v187, s54, v187
    v_cvt_pk_bf16_f32 v118, v180, v181
    v_cvt_pk_bf16_f32 v119, v182, v183
    v_cvt_pk_bf16_f32 v120, v184, v185
    v_cvt_pk_bf16_f32 v121, v186, v187
    v_cvt_pk_bf16_f32 v122, v188, v189
    v_cvt_pk_bf16_f32 v123, v190, v191
    v_mfma_f32_32x32x16_bf16 v[192:207], v[72:75], v[116:119], v[192:207]
    ds_read_b128 v[68:71], v19 offset:8192
    v_mfma_f32_32x32x16_bf16 v[192:207], v[76:79], v[120:123], v[192:207]
    ds_read_b128 v[72:75], v20 offset:8192
    s_waitcnt lgkmcnt(3)
    v_mfma_f32_32x32x16_bf16 v[208:223], v[48:51], v[92:95], 0
    ds_read_b128 v[76:79], v21 offset:8192
    v_mfma_f32_32x32x16_bf16 v[208:223], v[52:55], v[96:99], v[208:223]
    ds_read_b64_tr_b16 v[48:49], v22
    ds_read_b64_tr_b16 v[50:51], v22 offset:2048
    s_nop 4
    v_exp_f32 v192, v192
    v_mfma_f32_32x32x16_bf16 v[208:223], v[56:59], v[100:103], v[208:223]
    ds_read_b64_tr_b16 v[52:53], v23
    ds_read_b64_tr_b16 v[54:55], v23 offset:2048
    v_exp_f32 v193, v193
    v_exp_f32 v194, v194
    v_exp_f32 v195, v195
    v_mfma_f32_32x32x16_bf16 v[208:223], v[60:63], v[104:107], v[208:223]
    ds_read_b64_tr_b16 v[56:57], v24
    ds_read_b64_tr_b16 v[58:59], v24 offset:2048
    v_exp_f32 v196, v196
    v_exp_f32 v197, v197
    v_cvt_pk_bf16_f32 v80, v192, v193
    s_waitcnt lgkmcnt(6)
    v_mfma_f32_32x32x16_bf16 v[208:223], v[64:67], v[108:111], v[208:223]
    ds_read_b64_tr_b16 v[60:61], v25
    ds_read_b64_tr_b16 v[62:63], v25 offset:2048
    v_exp_f32 v198, v198
    v_exp_f32 v199, v199
    v_cvt_pk_bf16_f32 v81, v194, v195
    v_mfma_f32_32x32x16_bf16 v[208:223], v[68:71], v[112:115], v[208:223]
    ds_read_b64_tr_b16 v[64:65], v22 offset:4096
    ds_read_b64_tr_b16 v[66:67], v22 offset:6144
    v_exp_f32 v200, v200
    v_cvt_pk_bf16_f32 v82, v196, v197
    v_cvt_pk_bf16_f32 v83, v198, v199
    v_mfma_f32_32x32x16_bf16 v[208:223], v[72:75], v[116:119], v[208:223]
    ds_read_b64_tr_b16 v[68:69], v23 offset:4096
    ds_read_b64_tr_b16 v[70:71], v23 offset:6144
    v_exp_f32 v201, v201
    v_exp_f32 v202, v202
    v_cvt_pk_bf16_f32 v84, v200, v201
    v_mfma_f32_32x32x16_bf16 v[208:223], v[76:79], v[120:123], v[208:223]
    ds_read_b64_tr_b16 v[72:73], v24 offset:4096
    ds_read_b64_tr_b16 v[74:75], v24 offset:6144
    v_exp_f32 v203, v203
    v_exp_f32 v204, v204
    s_waitcnt lgkmcnt(6)
    v_mfma_f32_32x32x16_bf16 v[128:143], v[48:51], v[80:83], 0
    ds_read_b64_tr_b16 v[76:77], v25 offset:4096
    ds_read_b64_tr_b16 v[78:79], v25 offset:6144
    v_exp_f32 v205, v205
    v_exp_f32 v206, v206
    v_cvt_pk_bf16_f32 v85, v202, v203
    v_mfma_f32_32x32x16_bf16 v[144:159], v[52:55], v[80:83], 0
    s_barrier
    ds_read_b128 v[48:51], v14 offset:16384
    v_exp_f32 v207, v207
    v_cvt_pk_bf16_f32 v86, v204, v205
    v_add_f32 v36, v36, v192
    v_mfma_f32_32x32x16_bf16 v[160:175], v[56:59], v[80:83], 0
    ds_read_b128 v[52:55], v15 offset:16384
    v_cvt_pk_bf16_f32 v87, v206, v207
    v_add_f32 v37, v37, v193
    v_add_f32 v36, v36, v194
    v_add_f32 v37, v37, v195
    v_add_f32 v36, v36, v196
    s_cmp_lg_u32 s3, 0
    s_cbranch_scc1 L_w0_rl
    buffer_load_dword v40, v241, s[36:39], 0 offen sc1
L_w0_rl:
    v_mfma_f32_32x32x16_bf16 v[176:191], v[60:63], v[80:83], 0
    ds_read_b128 v[56:59], v16 offset:16384
    v_add_f32 v37, v37, v197
    v_add_f32 v36, v36, v198
    v_add_f32 v37, v37, v199
    v_exp_f32 v208, v208
    s_waitcnt lgkmcnt(3)
    v_mfma_f32_32x32x16_bf16 v[128:143], v[64:67], v[84:87], v[128:143]
    ds_read_b128 v[60:63], v17 offset:16384
    v_add_f32 v36, v36, v200
    v_add_f32 v37, v37, v201
    v_exp_f32 v209, v209
    v_exp_f32 v210, v210
    v_mfma_f32_32x32x16_bf16 v[144:159], v[68:71], v[84:87], v[144:159]
    ds_read_b128 v[64:67], v18 offset:16384
    v_add_f32 v36, v36, v202
    v_add_f32 v37, v37, v203
    v_exp_f32 v211, v211
    v_exp_f32 v212, v212
    v_cvt_pk_bf16_f32 v80, v208, v209
    v_mfma_f32_32x32x16_bf16 v[160:175], v[72:75], v[84:87], v[160:175]
    ds_read_b128 v[68:71], v19 offset:16384
    v_add_f32 v36, v36, v204
    v_add_f32 v37, v37, v205
    v_exp_f32 v213, v213
    v_exp_f32 v214, v214
    v_cvt_pk_bf16_f32 v81, v210, v211
    v_mfma_f32_32x32x16_bf16 v[176:191], v[76:79], v[84:87], v[176:191]
    ds_read_b128 v[72:75], v20 offset:16384
    v_add_f32 v36, v36, v206
    v_add_f32 v37, v37, v207
    v_exp_f32 v215, v215
    v_cvt_pk_bf16_f32 v82, v212, v213
    v_add_f32 v36, v36, v208
    s_waitcnt lgkmcnt(3)
    v_mfma_f32_32x32x16_bf16 v[192:207], v[48:51], v[92:95], 0
    ds_read_b128 v[76:79], v21 offset:16384
    v_exp_f32 v216, v216
    v_exp_f32 v217, v217
    v_cvt_pk_bf16_f32 v83, v214, v215
    v_mfma_f32_32x32x16_bf16 v[192:207], v[52:55], v[96:99], v[192:207]
    ds_read_b64_tr_b16 v[48:49], v22 offset:8192
    ds_read_b64_tr_b16 v[50:51], v22 offset:10240
    v_exp_f32 v218, v218
    v_cvt_pk_bf16_f32 v84, v216, v217
    v_mfma_f32_32x32x16_bf16 v[192:207], v[56:59], v[100:103], v[192:207]
    ds_read_b64_tr_b16 v[52:53], v23 offset:8192
    ds_read_b64_tr_b16 v[54:55], v23 offset:10240
    v_exp_f32 v219, v219
    v_add_f32 v37, v37, v209
    v_add_f32 v36, v36, v210
    v_mfma_f32_32x32x16_bf16 v[192:207], v[60:63], v[104:107], v[192:207]
    ds_read_b64_tr_b16 v[56:57], v24 offset:8192
    ds_read_b64_tr_b16 v[58:59], v24 offset:10240
    v_exp_f32 v220, v220
    v_cvt_pk_bf16_f32 v85, v218, v219
    s_waitcnt lgkmcnt(6)
    v_mfma_f32_32x32x16_bf16 v[192:207], v[64:67], v[108:111], v[192:207]
    ds_read_b64_tr_b16 v[60:61], v25 offset:8192
    ds_read_b64_tr_b16 v[62:63], v25 offset:10240
    v_exp_f32 v221, v221
    v_add_f32 v37, v37, v211
    v_add_f32 v36, v36, v212
    v_mfma_f32_32x32x16_bf16 v[192:207], v[68:71], v[112:115], v[192:207]
    ds_read_b64_tr_b16 v[64:65], v22 offset:12288
    ds_read_b64_tr_b16 v[66:67], v22 offset:14336
    v_exp_f32 v222, v222
    v_cvt_pk_bf16_f32 v86, v220, v221
    v_add_f32 v37, v37, v213
    v_mfma_f32_32x32x16_bf16 v[192:207], v[72:75], v[116:119], v[192:207]
    ds_read_b64_tr_b16 v[68:69], v23 offset:12288
    ds_read_b64_tr_b16 v[70:71], v23 offset:14336
    v_exp_f32 v223, v223
    v_add_f32 v36, v36, v214
    v_add_f32 v37, v37, v215
    v_mfma_f32_32x32x16_bf16 v[192:207], v[76:79], v[120:123], v[192:207]
    ds_read_b64_tr_b16 v[72:73], v24 offset:12288
    ds_read_b64_tr_b16 v[74:75], v24 offset:14336
    v_cvt_pk_bf16_f32 v87, v222, v223
    v_add_f32 v36, v36, v216
    s_waitcnt lgkmcnt(6)
    v_mfma_f32_32x32x16_bf16 v[128:143], v[48:51], v[80:83], v[128:143]
    ds_read_b64_tr_b16 v[76:77], v25 offset:12288
    ds_read_b64_tr_b16 v[78:79], v25 offset:14336
    v_add_f32 v37, v37, v217
    v_add_f32 v36, v36, v218
    v_add_f32 v37, v37, v219
    v_mfma_f32_32x32x16_bf16 v[144:159], v[52:55], v[80:83], v[144:159]
    s_barrier
    ds_read_b128 v[48:51], v14 offset:24576
    v_add_f32 v36, v36, v220
    v_add_f32 v37, v37, v221
    v_mfma_f32_32x32x16_bf16 v[160:175], v[56:59], v[80:83], v[160:175]
    ds_read_b128 v[52:55], v15 offset:24576
    v_add_f32 v36, v36, v222
    v_add_f32 v37, v37, v223
    v_mfma_f32_32x32x16_bf16 v[176:191], v[60:63], v[80:83], v[176:191]
    ds_read_b128 v[56:59], v16 offset:24576
    v_exp_f32 v192, v192
    s_waitcnt lgkmcnt(3)
    v_mfma_f32_32x32x16_bf16 v[128:143], v[64:67], v[84:87], v[128:143]
    ds_read_b128 v[60:63], v17 offset:24576
    v_exp_f32 v193, v193
    v_exp_f32 v194, v194
    v_mfma_f32_32x32x16_bf16 v[144:159], v[68:71], v[84:87], v[144:159]
    ds_read_b128 v[64:67], v18 offset:24576
    v_exp_f32 v195, v195
    v_exp_f32 v196, v196
    v_cvt_pk_bf16_f32 v80, v192, v193
    v_mfma_f32_32x32x16_bf16 v[160:175], v[72:75], v[84:87], v[160:175]
    ds_read_b128 v[68:71], v19 offset:24576
    v_exp_f32 v197, v197
    v_exp_f32 v198, v198
    v_cvt_pk_bf16_f32 v81, v194, v195
    v_mfma_f32_32x32x16_bf16 v[176:191], v[76:79], v[84:87], v[176:191]
    ds_read_b128 v[72:75], v20 offset:24576
    v_exp_f32 v199, v199
    v_cvt_pk_bf16_f32 v82, v196, v197
    v_add_f32 v36, v36, v192
    s_waitcnt lgkmcnt(3)
    v_mfma_f32_32x32x16_bf16 v[208:223], v[48:51], v[92:95], 0
    ds_read_b128 v[76:79], v21 offset:24576
    v_exp_f32 v200, v200
    v_exp_f32 v201, v201
    v_cvt_pk_bf16_f32 v83, v198, v199
    v_mfma_f32_32x32x16_bf16 v[208:223], v[52:55], v[96:99], v[208:223]
    ds_read_b64_tr_b16 v[48:49], v22 offset:16384
    ds_read_b64_tr_b16 v[50:51], v22 offset:18432
    v_exp_f32 v202, v202
    v_cvt_pk_bf16_f32 v84, v200, v201
    v_mfma_f32_32x32x16_bf16 v[208:223], v[56:59], v[100:103], v[208:223]
    ds_read_b64_tr_b16 v[52:53], v23 offset:16384
    ds_read_b64_tr_b16 v[54:55], v23 offset:18432
    v_exp_f32 v203, v203
    v_add_f32 v37, v37, v193
    v_add_f32 v36, v36, v194
    v_mfma_f32_32x32x16_bf16 v[208:223], v[60:63], v[104:107], v[208:223]
    ds_read_b64_tr_b16 v[56:57], v24 offset:16384
    ds_read_b64_tr_b16 v[58:59], v24 offset:18432
    v_exp_f32 v204, v204
    v_cvt_pk_bf16_f32 v85, v202, v203
    s_waitcnt lgkmcnt(6)
    v_mfma_f32_32x32x16_bf16 v[208:223], v[64:67], v[108:111], v[208:223]
    ds_read_b64_tr_b16 v[60:61], v25 offset:16384
    ds_read_b64_tr_b16 v[62:63], v25 offset:18432
    v_exp_f32 v205, v205
    v_add_f32 v37, v37, v195
    v_add_f32 v36, v36, v196
    v_mfma_f32_32x32x16_bf16 v[208:223], v[68:71], v[112:115], v[208:223]
    ds_read_b64_tr_b16 v[64:65], v22 offset:20480
    ds_read_b64_tr_b16 v[66:67], v22 offset:22528
    v_exp_f32 v206, v206
    v_cvt_pk_bf16_f32 v86, v204, v205
    v_add_f32 v37, v37, v197
    v_mfma_f32_32x32x16_bf16 v[208:223], v[72:75], v[116:119], v[208:223]
    ds_read_b64_tr_b16 v[68:69], v23 offset:20480
    ds_read_b64_tr_b16 v[70:71], v23 offset:22528
    v_exp_f32 v207, v207
    v_add_f32 v36, v36, v198
    v_add_f32 v37, v37, v199
    v_mfma_f32_32x32x16_bf16 v[208:223], v[76:79], v[120:123], v[208:223]
    ds_read_b64_tr_b16 v[72:73], v24 offset:20480
    ds_read_b64_tr_b16 v[74:75], v24 offset:22528
    v_cvt_pk_bf16_f32 v87, v206, v207
    v_add_f32 v36, v36, v200
    s_waitcnt lgkmcnt(6)
    v_mfma_f32_32x32x16_bf16 v[128:143], v[48:51], v[80:83], v[128:143]
    ds_read_b64_tr_b16 v[76:77], v25 offset:20480
    ds_read_b64_tr_b16 v[78:79], v25 offset:22528
    v_add_f32 v37, v37, v201
    v_add_f32 v36, v36, v202
    v_add_f32 v37, v37, v203
    v_mfma_f32_32x32x16_bf16 v[144:159], v[52:55], v[80:83], v[144:159]
    s_barrier
    ds_read_b128 v[48:51], v14
    v_add_f32 v36, v36, v204
    v_add_f32 v37, v37, v205
    v_mfma_f32_32x32x16_bf16 v[160:175], v[56:59], v[80:83], v[160:175]
    ds_read_b128 v[52:55], v15
    v_add_f32 v36, v36, v206
    v_add_f32 v37, v37, v207
    v_mfma_f32_32x32x16_bf16 v[176:191], v[60:63], v[80:83], v[176:191]
    ds_read_b128 v[56:59], v16
    v_exp_f32 v208, v208
    s_waitcnt lgkmcnt(3)
    v_mfma_f32_32x32x16_bf16 v[128:143], v[64:67], v[84:87], v[128:143]
    ds_read_b128 v[60:63], v17
    v_exp_f32 v209, v209
    v_exp_f32 v210, v210
    v_mfma_f32_32x32x16_bf16 v[144:159], v[68:71], v[84:87], v[144:159]
    ds_read_b128 v[64:67], v18
    v_exp_f32 v211, v211
    v_exp_f32 v212, v212
    v_cvt_pk_bf16_f32 v80, v208, v209
    v_mfma_f32_32x32x16_bf16 v[160:175], v[72:75], v[84:87], v[160:175]
    ds_read_b128 v[68:71], v19
    v_exp_f32 v213, v213
    v_exp_f32 v214, v214
    v_cvt_pk_bf16_f32 v81, v210, v211
    v_mfma_f32_32x32x16_bf16 v[176:191], v[76:79], v[84:87], v[176:191]
    ds_read_b128 v[72:75], v20
    v_exp_f32 v215, v215
    v_cvt_pk_bf16_f32 v82, v212, v213
    v_add_f32 v36, v36, v208
    s_waitcnt lgkmcnt(3)
    v_mfma_f32_32x32x16_bf16 v[192:207], v[48:51], v[92:95], 0
    ds_read_b128 v[76:79], v21
    v_exp_f32 v216, v216
    v_exp_f32 v217, v217
    v_cvt_pk_bf16_f32 v83, v214, v215
    v_mfma_f32_32x32x16_bf16 v[192:207], v[52:55], v[96:99], v[192:207]
    ds_read_b64_tr_b16 v[48:49], v22 offset:24576
    ds_read_b64_tr_b16 v[50:51], v22 offset:26624
    v_exp_f32 v218, v218
    v_cvt_pk_bf16_f32 v84, v216, v217
    v_mfma_f32_32x32x16_bf16 v[192:207], v[56:59], v[100:103], v[192:207]
    ds_read_b64_tr_b16 v[52:53], v23 offset:24576
    ds_read_b64_tr_b16 v[54:55], v23 offset:26624
    v_exp_f32 v219, v219
    v_add_f32 v37, v37, v209
    v_add_f32 v36, v36, v210
    v_mfma_f32_32x32x16_bf16 v[192:207], v[60:63], v[104:107], v[192:207]
    ds_read_b64_tr_b16 v[56:57], v24 offset:24576
    ds_read_b64_tr_b16 v[58:59], v24 offset:26624
    v_exp_f32 v220, v220
    v_cvt_pk_bf16_f32 v85, v218, v219
    s_waitcnt lgkmcnt(6)
    v_mfma_f32_32x32x16_bf16 v[192:207], v[64:67], v[108:111], v[192:207]
    ds_read_b64_tr_b16 v[60:61], v25 offset:24576
    ds_read_b64_tr_b16 v[62:63], v25 offset:26624
    v_exp_f32 v221, v221
    v_add_f32 v37, v37, v211
    v_add_f32 v36, v36, v212
    v_mfma_f32_32x32x16_bf16 v[192:207], v[68:71], v[112:115], v[192:207]
    ds_read_b64_tr_b16 v[64:65], v22 offset:28672
    ds_read_b64_tr_b16 v[66:67], v22 offset:30720
    v_exp_f32 v222, v222
    v_cvt_pk_bf16_f32 v86, v220, v221
    v_add_f32 v37, v37, v213
    v_mfma_f32_32x32x16_bf16 v[192:207], v[72:75], v[116:119], v[192:207]
    ds_read_b64_tr_b16 v[68:69], v23 offset:28672
    ds_read_b64_tr_b16 v[70:71], v23 offset:30720
    v_exp_f32 v223, v223
    v_add_f32 v36, v36, v214
    v_add_f32 v37, v37, v215
    v_mfma_f32_32x32x16_bf16 v[192:207], v[76:79], v[120:123], v[192:207]
    ds_read_b64_tr_b16 v[72:73], v24 offset:28672
    ds_read_b64_tr_b16 v[74:75], v24 offset:30720
    v_cvt_pk_bf16_f32 v87, v222, v223
    v_add_f32 v36, v36, v216
    s_waitcnt lgkmcnt(6)
    v_mfma_f32_32x32x16_bf16 v[128:143], v[48:51], v[80:83], v[128:143]
    ds_read_b64_tr_b16 v[76:77], v25 offset:28672
    ds_read_b64_tr_b16 v[78:79], v25 offset:30720
    v_add_f32 v37, v37, v217
    v_add_f32 v36, v36, v218
    v_add_f32 v37, v37, v219
    v_mfma_f32_32x32x16_bf16 v[144:159], v[52:55], v[80:83], v[144:159]
    s_barrier
    ds_read_b128 v[48:51], v14 offset:8192
    v_add_f32 v36, v36, v220
    v_add_f32 v37, v37, v221
    v_mfma_f32_32x32x16_bf16 v[160:175], v[56:59], v[80:83], v[160:175]
    ds_read_b128 v[52:55], v15 offset:8192
    v_add_f32 v36, v36, v222
    v_add_f32 v37, v37, v223
    v_mfma_f32_32x32x16_bf16 v[176:191], v[60:63], v[80:83], v[176:191]
    ds_read_b128 v[56:59], v16 offset:8192
    v_exp_f32 v192, v192
    s_waitcnt lgkmcnt(3)
    v_mfma_f32_32x32x16_bf16 v[128:143], v[64:67], v[84:87], v[128:143]
    ds_read_b128 v[60:63], v17 offset:8192
    v_exp_f32 v193, v193
    v_exp_f32 v194, v194
    v_mfma_f32_32x32x16_bf16 v[144:159], v[68:71], v[84:87], v[144:159]
    ds_read_b128 v[64:67], v18 offset:8192
    v_exp_f32 v195, v195
    v_exp_f32 v196, v196
    v_cvt_pk_bf16_f32 v80, v192, v193
    v_mfma_f32_32x32x16_bf16 v[160:175], v[72:75], v[84:87], v[160:175]
    ds_read_b128 v[68:71], v19 offset:8192
    v_exp_f32 v197, v197
    v_exp_f32 v198, v198
    v_cvt_pk_bf16_f32 v81, v194, v195
    v_mfma_f32_32x32x16_bf16 v[176:191], v[76:79], v[84:87], v[176:191]
    ds_read_b128 v[72:75], v20 offset:8192
    v_exp_f32 v199, v199
    v_cvt_pk_bf16_f32 v82, v196, v197
    v_add_f32 v36, v36, v192
    s_waitcnt lgkmcnt(3)
    v_mfma_f32_32x32x16_bf16 v[208:223], v[48:51], v[92:95], 0
    ds_read_b128 v[76:79], v21 offset:8192
    v_exp_f32 v200, v200
    v_exp_f32 v201, v201
    v_cvt_pk_bf16_f32 v83, v198, v199
    v_mfma_f32_32x32x16_bf16 v[208:223], v[52:55], v[96:99], v[208:223]
    ds_read_b64_tr_b16 v[48:49], v22
    ds_read_b64_tr_b16 v[50:51], v22 offset:2048
    v_exp_f32 v202, v202
    v_cvt_pk_bf16_f32 v84, v200, v201
    v_mfma_f32_32x32x16_bf16 v[208:223], v[56:59], v[100:103], v[208:223]
    ds_read_b64_tr_b16 v[52:53], v23
    ds_read_b64_tr_b16 v[54:55], v23 offset:2048
    v_exp_f32 v203, v203
    v_add_f32 v37, v37, v193
    v_add_f32 v36, v36, v194
    v_mfma_f32_32x32x16_bf16 v[208:223], v[60:63], v[104:107], v[208:223]
    ds_read_b64_tr_b16 v[56:57], v24
    ds_read_b64_tr_b16 v[58:59], v24 offset:2048
    v_exp_f32 v204, v204
    v_cvt_pk_bf16_f32 v85, v202, v203
    s_waitcnt lgkmcnt(6)
    v_mfma_f32_32x32x16_bf16 v[208:223], v[64:67], v[108:111], v[208:223]
    ds_read_b64_tr_b16 v[60:61], v25
    ds_read_b64_tr_b16 v[62:63], v25 offset:2048
    v_exp_f32 v205, v205
    v_add_f32 v37, v37, v195
    v_add_f32 v36, v36, v196
    v_mfma_f32_32x32x16_bf16 v[208:223], v[68:71], v[112:115], v[208:223]
    ds_read_b64_tr_b16 v[64:65], v22 offset:4096
    ds_read_b64_tr_b16 v[66:67], v22 offset:6144
    v_exp_f32 v206, v206
    v_cvt_pk_bf16_f32 v86, v204, v205
    v_add_f32 v37, v37, v197
    v_mfma_f32_32x32x16_bf16 v[208:223], v[72:75], v[116:119], v[208:223]
    ds_read_b64_tr_b16 v[68:69], v23 offset:4096
    ds_read_b64_tr_b16 v[70:71], v23 offset:6144
    v_exp_f32 v207, v207
    v_add_f32 v36, v36, v198
    v_add_f32 v37, v37, v199
    v_mfma_f32_32x32x16_bf16 v[208:223], v[76:79], v[120:123], v[208:223]
    ds_read_b64_tr_b16 v[72:73], v24 offset:4096
    ds_read_b64_tr_b16 v[74:75], v24 offset:6144
    v_cvt_pk_bf16_f32 v87, v206, v207
    v_add_f32 v36, v36, v200
    s_waitcnt lgkmcnt(6)
    v_mfma_f32_32x32x16_bf16 v[128:143], v[48:51], v[80:83], v[128:143]
    ds_read_b64_tr_b16 v[76:77], v25 offset:4096
    ds_read_b64_tr_b16 v[78:79], v25 offset:6144
    v_add_f32 v37, v37, v201
    v_add_f32 v36, v36, v202
    v_add_f32 v37, v37, v203
    v_mfma_f32_32x32x16_bf16 v[144:159], v[52:55], v[80:83], v[144:159]
    s_mov_b32 s56, 0
    s_cmp_lg_u32 s3, 0
    s_cbranch_scc1 L_w0_rdy
L_rdy:
    s_waitcnt vmcnt(0)
    v_readfirstlane_b32 s43, v40
    s_nop 0
    s_cmp_eq_u32 s43, 1
    s_cbranch_scc1 L_rdyok
    buffer_load_dword v40, v241, s[36:39], 0 offen sc1
    s_add_u32 s56, s56, 1
    s_cmp_lt_u32 s56, 0x40000
    s_cbranch_scc1 L_rdy
L_rdyok:
L_w0_rdy:
    s_barrier
    ds_read_b128 v[48:51], v14 offset:16384
    v_add_f32 v36, v36, v204
    v_add_f32 v37, v37, v205
    v_mfma_f32_32x32x16_bf16 v[160:175], v[56:59], v[80:83], v[160:175]
    ds_read_b128 v[52:55], v15 offset:16384
    v_add_f32 v36, v36, v206
    v_add_f32 v37, v37, v207
    v_mfma_f32_32x32x16_bf16 v[176:191], v[60:63], v[80:83], v[176:191]
    ds_read_b128 v[56:59], v16 offset:16384
    v_exp_f32 v208, v208
    s_waitcnt lgkmcnt(3)
    v_mfma_f32_32x32x16_bf16 v[128:143], v[64:67], v[84:87], v[128:143]
    ds_read_b128 v[60:63], v17 offset:16384
    v_exp_f32 v209, v209
    v_exp_f32 v210, v210
    v_mfma_f32_32x32x16_bf16 v[144:159], v[68:71], v[84:87], v[144:159]
    ds_read_b128 v[64:67], v18 offset:16384
    v_exp_f32 v211, v211
    v_exp_f32 v212, v212
    v_cvt_pk_bf16_f32 v80, v208, v209
    v_mfma_f32_32x32x16_bf16 v[160:175], v[72:75], v[84:87], v[160:175]
    ds_read_b128 v[68:71], v19 offset:16384
    v_exp_f32 v213, v213
    v_exp_f32 v214, v214
    v_cvt_pk_bf16_f32 v81, v210, v211
    v_mfma_f32_32x32x16_bf16 v[176:191], v[76:79], v[84:87], v[176:191]
    ds_read_b128 v[72:75], v20 offset:16384
    v_exp_f32 v215, v215
    v_cvt_pk_bf16_f32 v82, v212, v213
    v_add_f32 v36, v36, v208
    s_waitcnt lgkmcnt(3)
    v_mfma_f32_32x32x16_bf16 v[192:207], v[48:51], v[92:95], 0
    ds_read_b128 v[76:79], v21 offset:16384
    v_exp_f32 v216, v216
    v_exp_f32 v217, v217
    v_cvt_pk_bf16_f32 v83, v214, v215
    v_mfma_f32_32x32x16_bf16 v[192:207], v[52:55], v[96:99], v[192:207]
    ds_read_b64_tr_b16 v[48:49], v22 offset:8192
    ds_read_b64_tr_b16 v[50:51], v22 offset:10240
    v_exp_f32 v218, v218
    v_cvt_pk_bf16_f32 v84, v216, v217
    v_mfma_f32_32x32x16_bf16 v[192:207], v[56:59], v[100:103], v[192:207]
    ds_read_b64_tr_b16 v[52:53], v23 offset:8192
    ds_read_b64_tr_b16 v[54:55], v23 offset:10240
    v_exp_f32 v219, v219
    v_add_f32 v37, v37, v209
    v_add_f32 v36, v36, v210
    v_mfma_f32_32x32x16_bf16 v[192:207], v[60:63], v[104:107], v[192:207]
    ds_read_b64_tr_b16 v[56:57], v24 offset:8192
    ds_read_b64_tr_b16 v[58:59], v24 offset:10240
    v_exp_f32 v220, v220
    v_cvt_pk_bf16_f32 v85, v218, v219
    s_waitcnt lgkmcnt(6)
    v_mfma_f32_32x32x16_bf16 v[192:207], v[64:67], v[108:111], v[192:207]
    ds_read_b64_tr_b16 v[60:61], v25 offset:8192
    ds_read_b64_tr_b16 v[62:63], v25 offset:10240
    v_exp_f32 v221, v221
    v_add_f32 v37, v37, v211
    v_add_f32 v36, v36, v212
    v_mfma_f32_32x32x16_bf16 v[192:207], v[68:71], v[112:115], v[192:207]
    ds_read_b64_tr_b16 v[64:65], v22 offset:12288
    ds_read_b64_tr_b16 v[66:67], v22 offset:14336
    v_exp_f32 v222, v222
    v_cvt_pk_bf16_f32 v86, v220, v221
    v_add_f32 v37, v37, v213
    v_mfma_f32_32x32x16_bf16 v[192:207], v[72:75], v[116:119], v[192:207]
    ds_read_b64_tr_b16 v[68:69], v23 offset:12288
    ds_read_b64_tr_b16 v[70:71], v23 offset:14336
    v_exp_f32 v223, v223
    v_add_f32 v36, v36, v214
    v_add_f32 v37, v37, v215
    v_mfma_f32_32x32x16_bf16 v[192:207], v[76:79], v[120:123], v[192:207]
    ds_read_b64_tr_b16 v[72:73], v24 offset:12288
    ds_read_b64_tr_b16 v[74:75], v24 offset:14336
    v_cvt_pk_bf16_f32 v87, v222, v223
    v_add_f32 v36, v36, v216
    s_waitcnt lgkmcnt(6)
    v_mfma_f32_32x32x16_bf16 v[128:143], v[48:51], v[80:83], v[128:143]
    ds_read_b64_tr_b16 v[76:77], v25 offset:12288
    ds_read_b64_tr_b16 v[78:79], v25 offset:14336
    v_add_f32 v37, v37, v217
    v_add_f32 v36, v36, v218
    v_add_f32 v37, v37, v219
    v_mfma_f32_32x32x16_bf16 v[144:159], v[52:55], v[80:83], v[144:159]
    s_barrier
    ds_read_b128 v[48:51], v14 offset:24576
    v_add_f32 v36, v36, v220
    v_add_f32 v37, v37, v221
    v_mfma_f32_32x32x16_bf16 v[160:175], v[56:59], v[80:83], v[160:175]
    ds_read_b128 v[52:55], v15 offset:24576
    v_add_f32 v36, v36, v222
    v_add_f32 v37, v37, v223
    v_mfma_f32_32x32x16_bf16 v[176:191], v[60:63], v[80:83], v[176:191]
    ds_read_b128 v[56:59], v16 offset:24576
    v_exp_f32 v192, v192
    s_waitcnt lgkmcnt(3)
    v_mfma_f32_32x32x16_bf16 v[128:143], v[64:67], v[84:87], v[128:143]
    ds_read_b128 v[60:63], v17 offset:24576
    v_exp_f32 v193, v193
    v_exp_f32 v194, v194
    v_mfma_f32_32x32x16_bf16 v[144:159], v[68:71], v[84:87], v[144:159]
    ds_read_b128 v[64:67], v18 offset:24576
    v_exp_f32 v195, v195
    v_exp_f32 v196, v196
    v_cvt_pk_bf16_f32 v80, v192, v193
    v_mfma_f32_32x32x16_bf16 v[160:175], v[72:75], v[84:87], v[160:175]
    ds_read_b128 v[68:71], v19 offset:24576
    v_exp_f32 v197, v197
    v_exp_f32 v198, v198
    v_cvt_pk_bf16_f32 v81, v194, v195
    v_mfma_f32_32x32x16_bf16 v[176:191], v[76:79], v[84:87], v[176:191]
    ds_read_b128 v[72:75], v20 offset:24576
    v_exp_f32 v199, v199
    v_cvt_pk_bf16_f32 v82, v196, v197
    v_add_f32 v36, v36, v192
    s_waitcnt lgkmcnt(3)
    v_mfma_f32_32x32x16_bf16 v[208:223], v[48:51], v[92:95], 0
    ds_read_b128 v[76:79], v21 offset:24576
    v_exp_f32 v200, v200
    v_exp_f32 v201, v201
    v_cvt_pk_bf16_f32 v83, v198, v199
    v_mfma_f32_32x32x16_bf16 v[208:223], v[52:55], v[96:99], v[208:223]
    ds_read_b64_tr_b16 v[48:49], v22 offset:16384
    ds_read_b64_tr_b16 v[50:51], v22 offset:18432
    v_exp_f32 v202, v202
    v_cvt_pk_bf16_f32 v84, v200, v201
    v_mfma_f32_32x32x16_bf16 v[208:223], v[56:59], v[100:103], v[208:223]
    ds_read_b64_tr_b16 v[52:53], v23 offset:16384
    ds_read_b64_tr_b16 v[54:55], v23 offset:18432
    v_exp_f32 v203, v203
    v_add_f32 v37, v37, v193
    v_add_f32 v36, v36, v194
    v_mfma_f32_32x32x16_bf16 v[208:223], v[60:63], v[104:107], v[208:223]
    ds_read_b64_tr_b16 v[56:57], v24 offset:16384
    ds_read_b64_tr_b16 v[58:59], v24 offset:18432
    v_exp_f32 v204, v204
    v_cvt_pk_bf16_f32 v85, v202, v203
    s_waitcnt lgkmcnt(6)
    v_mfma_f32_32x32x16_bf16 v[208:223], v[64:67], v[108:111], v[208:223]
    ds_read_b64_tr_b16 v[60:61], v25 offset:16384
    ds_read_b64_tr_b16 v[62:63], v25 offset:18432
    v_exp_f32 v205, v205
    v_add_f32 v37, v37, v195
    v_add_f32 v36, v36, v196
    v_mfma_f32_32x32x16_bf16 v[208:223], v[68:71], v[112:115], v[208:223]
    ds_read_b64_tr_b16 v[64:65], v22 offset:20480
    ds_read_b64_tr_b16 v[66:67], v22 offset:22528
    v_exp_f32 v206, v206
    v_cvt_pk_bf16_f32 v86, v204, v205
    v_add_f32 v37, v37, v197
    v_mfma_f32_32x32x16_bf16 v[208:223], v[72:75], v[116:119], v[208:223]
    ds_read_b64_tr_b16 v[68:69], v23 offset:20480
    ds_read_b64_tr_b16 v[70:71], v23 offset:22528
    v_exp_f32 v207, v207
    v_add_f32 v36, v36, v198
    v_add_f32 v37, v37, v199
    v_mfma_f32_32x32x16_bf16 v[208:223], v[76:79], v[120:123], v[208:223]
    ds_read_b64_tr_b16 v[72:73], v24 offset:20480
    ds_read_b64_tr_b16 v[74:75], v24 offset:22528
    v_cvt_pk_bf16_f32 v87, v206, v207
    v_add_f32 v36, v36, v200
    s_waitcnt lgkmcnt(6)
    v_mfma_f32_32x32x16_bf16 v[128:143], v[48:51], v[80:83], v[128:143]
    ds_read_b64_tr_b16 v[76:77], v25 offset:20480
    ds_read_b64_tr_b16 v[78:79], v25 offset:22528
    v_add_f32 v37, v37, v201
    v_add_f32 v36, v36, v202
    v_add_f32 v37, v37, v203
    v_mfma_f32_32x32x16_bf16 v[144:159], v[52:55], v[80:83], v[144:159]
    s_barrier
    ds_read_b128 v[48:51], v14
    v_add_f32 v36, v36, v204
    v_add_f32 v37, v37, v205
    v_mfma_f32_32x32x16_bf16 v[160:175], v[56:59], v[80:83], v[160:175]
    ds_read_b128 v[52:55], v15
    v_add_f32 v36, v36, v206
    v_add_f32 v37, v37, v207
    v_mfma_f32_32x32x16_bf16 v[176:191], v[60:63], v[80:83], v[176:191]
    ds_read_b128 v[56:59], v16
    v_exp_f32 v208, v208
    s_waitcnt lgkmcnt(3)
    s_nop 0
L_mk4:
    s_cbranch_execz L_rt4
    v_mfma_f32_32x32x16_bf16 v[128:143], v[64:67], v[84:87], v[128:143]
    ds_read_b128 v[60:63], v17
    v_exp_f32 v209, v209
    v_exp_f32 v210, v210
    v_mfma_f32_32x32x16_bf16 v[144:159], v[68:71], v[84:87], v[144:159]
    ds_read_b128 v[64:67], v18
    v_exp_f32 v211, v211
    v_exp_f32 v212, v212
    v_cvt_pk_bf16_f32 v80, v208, v209
    v_mfma_f32_32x32x16_bf16 v[160:175], v[72:75], v[84:87], v[160:175]
    ds_read_b128 v[68:71], v19
    v_exp_f32 v213, v213
    v_exp_f32 v214, v214
    v_cvt_pk_bf16_f32 v81, v210, v211
    v_mfma_f32_32x32x16_bf16 v[176:191], v[76:79], v[84:87], v[176:191]
    ds_read_b128 v[72:75], v20
    v_exp_f32 v215, v215
    v_cvt_pk_bf16_f32 v82, v212, v213
    v_add_f32 v36, v36, v208
    s_waitcnt lgkmcnt(3)
    v_mfma_f32_32x32x16_bf16 v[192:207], v[48:51], v[92:95], 0
    ds_read_b128 v[76:79], v21
    v_exp_f32 v216, v216
    v_exp_f32 v217, v217
    v_cvt_pk_bf16_f32 v83, v214, v215
    v_mfma_f32_32x32x16_bf16 v[192:207], v[52:55], v[96:99], v[192:207]
    ds_read_b64_tr_b16 v[48:49], v22 offset:24576
    ds_read_b64_tr_b16 v[50:51], v22 offset:26624
    v_exp_f32 v218, v218
    v_cvt_pk_bf16_f32 v84, v216, v217
    v_mfma_f32_32x32x16_bf16 v[192:207], v[56:59], v[100:103], v[192:207]
    ds_read_b64_tr_b16 v[52:53], v23 offset:24576
    ds_read_b64_tr_b16 v[54:55], v23 offset:26624
    v_exp_f32 v219, v219
    v_add_f32 v37, v37, v209
    v_add_f32 v36, v36, v210
    v_mfma_f32_32x32x16_bf16 v[192:207], v[60:63], v[104:107], v[192:207]
    ds_read_b64_tr_b16 v[56:57], v24 offset:24576
    ds_read_b64_tr_b16 v[58:59], v24 offset:26624
    v_exp_f32 v220, v220
    v_cvt_pk_bf16_f32 v85, v218, v219
    s_waitcnt lgkmcnt(6)
    v_mfma_f32_32x32x16_bf16 v[192:207], v[64:67], v[108:111], v[192:207]
    ds_read_b64_tr_b16 v[60:61], v25 offset:24576
    ds_read_b64_tr_b16 v[62:63], v25 offset:26624
    v_exp_f32 v221, v221
    v_add_f32 v37, v37, v211
    v_add_f32 v36, v36, v212
    v_mfma_f32_32x32x16_bf16 v[192:207], v[68:71], v[112:115], v[192:207]
    ds_read_b64_tr_b16 v[64:65], v22 offset:28672
    ds_read_b64_tr_b16 v[66:67], v22 offset:30720
    v_exp_f32 v222, v222
    v_cvt_pk_bf16_f32 v86, v220, v221
    v_add_f32 v37, v37, v213
    v_mfma_f32_32x32x16_bf16 v[192:207], v[72:75], v[116:119], v[192:207]
    ds_read_b64_tr_b16 v[68:69], v23 offset:28672
    ds_read_b64_tr_b16 v[70:71], v23 offset:30720
    v_exp_f32 v223, v223
    v_add_f32 v36, v36, v214
    v_add_f32 v37, v37, v215
    v_mfma_f32_32x32x16_bf16 v[192:207], v[76:79], v[120:123], v[192:207]
    ds_read_b64_tr_b16 v[72:73], v24 offset:28672
    ds_read_b64_tr_b16 v[74:75], v24 offset:30720
    v_cvt_pk_bf16_f32 v87, v222, v223
    v_add_f32 v36, v36, v216
    s_waitcnt lgkmcnt(6)
    v_mfma_f32_32x32x16_bf16 v[128:143], v[48:51], v[80:83], v[128:143]
    ds_read_b64_tr_b16 v[76:77], v25 offset:28672
    ds_read_b64_tr_b16 v[78:79], v25 offset:30720
    v_add_f32 v37, v37, v217
    v_add_f32 v36, v36, v218
    v_add_f32 v37, v37, v219
    v_mfma_f32_32x32x16_bf16 v[144:159], v[52:55], v[80:83], v[144:159]
    s_barrier
    ds_read_b128 v[48:51], v14 offset:8192
    v_add_f32 v36, v36, v220
    v_add_f32 v37, v37, v221
    v_mfma_f32_32x32x16_bf16 v[160:175], v[56:59], v[80:83], v[160:175]
    ds_read_b128 v[52:55], v15 offset:8192
    v_add_f32 v36, v36, v222
    v_add_f32 v37, v37, v223
    v_mfma_f32_32x32x16_bf16 v[176:191], v[60:63], v[80:83], v[176:191]
    ds_read_b128 v[56:59], v16 offset:8192
    v_exp_f32 v192, v192
    s_waitcnt lgkmcnt(3)
    v_mfma_f32_32x32x16_bf16 v[128:143], v[64:67], v[84:87], v[128:143]
    ds_read_b128 v[60:63], v17 offset:8192
    v_exp_f32 v193, v193
    v_exp_f32 v194, v194
    v_mfma_f32_32x32x16_bf16 v[144:159], v[68:71], v[84:87], v[144:159]
    ds_read_b128 v[64:67], v18 offset:8192
    v_exp_f32 v195, v195
    v_exp_f32 v196, v196
    v_cvt_pk_bf16_f32 v80, v192, v193
    v_mfma_f32_32x32x16_bf16 v[160:175], v[72:75], v[84:87], v[160:175]
    ds_read_b128 v[68:71], v19 offset:8192
    v_exp_f32 v197, v197
    v_exp_f32 v198, v198
    v_cvt_pk_bf16_f32 v81, v194, v195
    v_mfma_f32_32x32x16_bf16 v[176:191], v[76:79], v[84:87], v[176:191]
    ds_read_b128 v[72:75], v20 offset:8192
    v_exp_f32 v199, v199
    v_cvt_pk_bf16_f32 v82, v196, v197
    v_add_f32 v36, v36, v192
    s_waitcnt lgkmcnt(3)
    v_mfma_f32_32x32x16_bf16 v[208:223], v[48:51], v[92:95], 0
    ds_read_b128 v[76:79], v21 offset:8192
    v_exp_f32 v200, v200
    v_exp_f32 v201, v201
    v_cvt_pk_bf16_f32 v83, v198, v199
    v_mfma_f32_32x32x16_bf16 v[208:223], v[52:55], v[96:99], v[208:223]
    ds_read_b64_tr_b16 v[48:49], v22
    ds_read_b64_tr_b16 v[50:51], v22 offset:2048
    v_exp_f32 v202, v202
    v_cvt_pk_bf16_f32 v84, v200, v201
    v_mfma_f32_32x32x16_bf16 v[208:223], v[56:59], v[100:103], v[208:223]
    ds_read_b64_tr_b16 v[52:53], v23
    ds_read_b64_tr_b16 v[54:55], v23 offset:2048
    v_exp_f32 v203, v203
    v_add_f32 v37, v37, v193
    v_add_f32 v36, v36, v194
    v_mfma_f32_32x32x16_bf16 v[208:223], v[60:63], v[104:107], v[208:223]
    ds_read_b64_tr_b16 v[56:57], v24
    ds_read_b64_tr_b16 v[58:59], v24 offset:2048
    v_exp_f32 v204, v204
    v_cvt_pk_bf16_f32 v85, v202, v203
    s_waitcnt lgkmcnt(6)
    v_mfma_f32_32x32x16_bf16 v[208:223], v[64:67], v[108:111], v[208:223]
    ds_read_b64_tr_b16 v[60:61], v25
    ds_read_b64_tr_b16 v[62:63], v25 offset:2048
    v_exp_f32 v205, v205
    v_add_f32 v37, v37, v195
    v_add_f32 v36, v36, v196
    v_mfma_f32_32x32x16_bf16 v[208:223], v[68:71], v[112:115], v[208:223]
    ds_read_b64_tr_b16 v[64:65], v22 offset:4096
    ds_read_b64_tr_b16 v[66:67], v22 offset:6144
    v_exp_f32 v206, v206
    v_cvt_pk_bf16_f32 v86, v204, v205
    v_add_f32 v37, v37, v197
    v_mfma_f32_32x32x16_bf16 v[208:223], v[72:75], v[116:119], v[208:223]
    ds_read_b64_tr_b16 v[68:69], v23 offset:4096
    ds_read_b64_tr_b16 v[70:71], v23 offset:6144
    v_exp_f32 v207, v207
    v_add_f32 v36, v36, v198
    v_add_f32 v37, v37, v199
    v_mfma_f32_32x32x16_bf16 v[208:223], v[76:79], v[120:123], v[208:223]
    ds_read_b64_tr_b16 v[72:73], v24 offset:4096
    ds_read_b64_tr_b16 v[74:75], v24 offset:6144
    v_cvt_pk_bf16_f32 v87, v206, v207
    v_add_f32 v36, v36, v200
    s_waitcnt lgkmcnt(6)
    v_mfma_f32_32x32x16_bf16 v[128:143], v[48:51], v[80:83], v[128:143]
    ds_read_b64_tr_b16 v[76:77], v25 offset:4096
    ds_read_b64_tr_b16 v[78:79], v25 offset:6144
    v_add_f32 v37, v37, v201
    v_add_f32 v36, v36, v202
    v_add_f32 v37, v37, v203
    v_mfma_f32_32x32x16_bf16 v[144:159], v[52:55], v[80:83], v[144:159]
    s_barrier
    ds_read_b128 v[48:51], v14 offset:16384
    v_add_f32 v36, v36, v204
    v_add_f32 v37, v37, v205
    v_mfma_f32_32x32x16_bf16 v[160:175], v[56:59], v[80:83], v[160:175]
    ds_read_b128 v[52:55], v15 offset:16384
    v_add_f32 v36, v36, v206
    v_add_f32 v37, v37, v207
    v_mfma_f32_32x32x16_bf16 v[176:191], v[60:63], v[80:83], v[176:191]
    ds_read_b128 v[56:59], v16 offset:16384
    v_exp_f32 v208, v208
    s_waitcnt lgkmcnt(3)
    v_mfma_f32_32x32x16_bf16 v[128:143], v[64:67], v[84:87], v[128:143]
    ds_read_b128 v[60:63], v17 offset:16384
    v_exp_f32 v209, v209
    v_exp_f32 v210, v210
    v_mfma_f32_32x32x16_bf16 v[144:159], v[68:71], v[84:87], v[144:159]
    ds_read_b128 v[64:67], v18 offset:16384
    v_exp_f32 v211, v211
    v_exp_f32 v212, v212
    v_cvt_pk_bf16_f32 v80, v208, v209
    v_mfma_f32_32x32x16_bf16 v[160:175], v[72:75], v[84:87], v[160:175]
    ds_read_b128 v[68:71], v19 offset:16384
    v_exp_f32 v213, v213
    v_exp_f32 v214, v214
    v_cvt_pk_bf16_f32 v81, v210, v211
    v_mfma_f32_32x32x16_bf16 v[176:191], v[76:79], v[84:87], v[176:191]
    ds_read_b128 v[72:75], v20 offset:16384
    v_exp_f32 v215, v215
    v_cvt_pk_bf16_f32 v82, v212, v213
    v_add_f32 v36, v36, v208
    s_waitcnt lgkmcnt(3)
    v_mfma_f32_32x32x16_bf16 v[192:207], v[48:51], v[92:95], 0
    ds_read_b128 v[76:79], v21 offset:16384
    v_exp_f32 v216, v216
    v_exp_f32 v217, v217
    v_cvt_pk_bf16_f32 v83, v214, v215
    v_mfma_f32_32x32x16_bf16 v[192:207], v[52:55], v[96:99], v[192:207]
    ds_read_b64_tr_b16 v[48:49], v22 offset:8192
    ds_read_b64_tr_b16 v[50:51], v22 offset:10240
    v_exp_f32 v218, v218
    v_cvt_pk_bf16_f32 v84, v216, v217
    v_mfma_f32_32x32x16_bf16 v[192:207], v[56:59], v[100:103], v[192:207]
    ds_read_b64_tr_b16 v[52:53], v23 offset:8192
    ds_read_b64_tr_b16 v[54:55], v23 offset:10240
    v_exp_f32 v219, v219
    v_add_f32 v37, v37, v209
    v_add_f32 v36, v36, v210
    v_mfma_f32_32x32x16_bf16 v[192:207], v[60:63], v[104:107], v[192:207]
    ds_read_b64_tr_b16 v[56:57], v24 offset:8192
    ds_read_b64_tr_b16 v[58:59], v24 offset:10240
    v_exp_f32 v220, v220
    v_cvt_pk_bf16_f32 v85, v218, v219
    s_waitcnt lgkmcnt(6)
    v_mfma_f32_32x32x16_bf16 v[192:207], v[64:67], v[108:111], v[192:207]
    ds_read_b64_tr_b16 v[60:61], v25 offset:8192
    ds_read_b64_tr_b16 v[62:63], v25 offset:10240
    v_exp_f32 v221, v221
    v_add_f32 v37, v37, v211
    v_add_f32 v36, v36, v212
    v_mfma_f32_32x32x16_bf16 v[192:207], v[68:71], v[112:115], v[192:207]
    ds_read_b64_tr_b16 v[64:65], v22 offset:12288
    ds_read_b64_tr_b16 v[66:67], v22 offset:14336
    v_exp_f32 v222, v222
    v_cvt_pk_bf16_f32 v86, v220, v221
    v_add_f32 v37, v37, v213
    v_mfma_f32_32x32x16_bf16 v[192:207], v[72:75], v[116:119], v[192:207]
    ds_read_b64_tr_b16 v[68:69], v23 offset:12288
    ds_read_b64_tr_b16 v[70:71], v23 offset:14336
    v_exp_f32 v223, v223
    v_add_f32 v36, v36, v214
    v_add_f32 v37, v37, v215
    v_mfma_f32_32x32x16_bf16 v[192:207], v[76:79], v[120:123], v[192:207]
    ds_read_b64_tr_b16 v[72:73], v24 offset:12288
    ds_read_b64_tr_b16 v[74:75], v24 offset:14336
    v_cvt_pk_bf16_f32 v87, v222, v223
    v_add_f32 v36, v36, v216
    s_waitcnt lgkmcnt(6)
    v_mfma_f32_32x32x16_bf16 v[128:143], v[48:51], v[80:83], v[128:143]
    ds_read_b64_tr_b16 v[76:77], v25 offset:12288
    ds_read_b64_tr_b16 v[78:79], v25 offset:14336
    v_add_f32 v37, v37, v217
    v_add_f32 v36, v36, v218
    v_add_f32 v37, v37, v219
    v_mfma_f32_32x32x16_bf16 v[144:159], v[52:55], v[80:83], v[144:159]
    s_barrier
    ds_read_b128 v[48:51], v14 offset:24576
    v_add_f32 v36, v36, v220
    v_add_f32 v37, v37, v221
    v_mfma_f32_32x32x16_bf16 v[160:175], v[56:59], v[80:83], v[160:175]
    ds_read_b128 v[52:55], v15 offset:24576
    v_add_f32 v36, v36, v222
    v_add_f32 v37, v37, v223
    v_mfma_f32_32x32x16_bf16 v[176:191], v[60:63], v[80:83], v[176:191]
    ds_read_b128 v[56:59], v16 offset:24576
    v_exp_f32 v192, v192
    s_waitcnt lgkmcnt(3)
    v_mfma_f32_32x32x16_bf16 v[128:143], v[64:67], v[84:87], v[128:143]
    ds_read_b128 v[60:63], v17 offset:24576
    v_exp_f32 v193, v193
    v_exp_f32 v194, v194
    v_mfma_f32_32x32x16_bf16 v[144:159], v[68:71], v[84:87], v[144:159]
    ds_read_b128 v[64:67], v18 offset:24576
    v_exp_f32 v195, v195
    v_exp_f32 v196, v196
    v_cvt_pk_bf16_f32 v80, v192, v193
    v_mfma_f32_32x32x16_bf16 v[160:175], v[72:75], v[84:87], v[160:175]
    ds_read_b128 v[68:71], v19 offset:24576
    v_exp_f32 v197, v197
    v_exp_f32 v198, v198
    v_cvt_pk_bf16_f32 v81, v194, v195
    v_mfma_f32_32x32x16_bf16 v[176:191], v[76:79], v[84:87], v[176:191]
    ds_read_b128 v[72:75], v20 offset:24576
    v_exp_f32 v199, v199
    v_cvt_pk_bf16_f32 v82, v196, v197
    v_add_f32 v36, v36, v192
    s_waitcnt lgkmcnt(3)
    v_mfma_f32_32x32x16_bf16 v[208:223], v[48:51], v[92:95], 0
    ds_read_b128 v[76:79], v21 offset:24576
    v_exp_f32 v200, v200
    v_exp_f32 v201, v201
    v_cvt_pk_bf16_f32 v83, v198, v199
    v_mfma_f32_32x32x16_bf16 v[208:223], v[52:55], v[96:99], v[208:223]
    ds_read_b64_tr_b16 v[48:49], v22 offset:16384
    ds_read_b64_tr_b16 v[50:51], v22 offset:18432
    v_exp_f32 v202, v202
    v_cvt_pk_bf16_f32 v84, v200, v201
    v_mfma_f32_32x32x16_bf16 v[208:223], v[56:59], v[100:103], v[208:223]
    ds_read_b64_tr_b16 v[52:53], v23 offset:16384
    ds_read_b64_tr_b16 v[54:55], v23 offset:18432
    v_exp_f32 v203, v203
    v_add_f32 v37, v37, v193
    v_add_f32 v36, v36, v194
    v_mfma_f32_32x32x16_bf16 v[208:223], v[60:63], v[104:107], v[208:223]
    ds_read_b64_tr_b16 v[56:57], v24 offset:16384
    ds_read_b64_tr_b16 v[58:59], v24 offset:18432
    v_exp_f32 v204, v204
    v_cvt_pk_bf16_f32 v85, v202, v203
    s_waitcnt lgkmcnt(6)
    v_mfma_f32_32x32x16_bf16 v[208:223], v[64:67], v[108:111], v[208:223]
    ds_read_b64_tr_b16 v[60:61], v25 offset:16384
    ds_read_b64_tr_b16 v[62:63], v25 offset:18432
    v_exp_f32 v205, v205
    v_add_f32 v37, v37, v195
    v_add_f32 v36, v36, v196
    v_mfma_f32_32x32x16_bf16 v[208:223], v[68:71], v[112:115], v[208:223]
    ds_read_b64_tr_b16 v[64:65], v22 offset:20480
    ds_read_b64_tr_b16 v[66:67], v22 offset:22528
    v_exp_f32 v206, v206
    v_cvt_pk_bf16_f32 v86, v204, v205
    v_add_f32 v37, v37, v197
    v_mfma_f32_32x32x16_bf16 v[208:223], v[72:75], v[116:119], v[208:223]
    ds_read_b64_tr_b16 v[68:69], v23 offset:20480
    ds_read_b64_tr_b16 v[70:71], v23 offset:22528
    v_exp_f32 v207, v207
    v_add_f32 v36, v36, v198
    v_add_f32 v37, v37, v199
    v_mfma_f32_32x32x16_bf16 v[208:223], v[76:79], v[120:123], v[208:223]
    ds_read_b64_tr_b16 v[72:73], v24 offset:20480
    ds_read_b64_tr_b16 v[74:75], v24 offset:22528
    v_cvt_pk_bf16_f32 v87, v206, v207
    v_add_f32 v36, v36, v200
    s_waitcnt lgkmcnt(6)
    v_mfma_f32_32x32x16_bf16 v[128:143], v[48:51], v[80:83], v[128:143]
    ds_read_b64_tr_b16 v[76:77], v25 offset:20480
    ds_read_b64_tr_b16 v[78:79], v25 offset:22528
    v_add_f32 v37, v37, v201
    v_add_f32 v36, v36, v202
    v_add_f32 v37, v37, v203
    v_mfma_f32_32x32x16_bf16 v[144:159], v[52:55], v[80:83], v[144:159]
    s_barrier
    ds_read_b128 v[48:51], v14
    v_add_f32 v36, v36, v204
    v_add_f32 v37, v37, v205
    v_mfma_f32_32x32x16_bf16 v[160:175], v[56:59], v[80:83], v[160:175]
    ds_read_b128 v[52:55], v15
    v_add_f32 v36, v36, v206
    v_add_f32 v37, v37, v207
    v_mfma_f32_32x32x16_bf16 v[176:191], v[60:63], v[80:83], v[176:191]
    ds_read_b128 v[56:59], v16
    v_exp_f32 v208, v208
    s_waitcnt lgkmcnt(3)
    v_mfma_f32_32x32x16_bf16 v[128:143], v[64:67], v[84:87], v[128:143]
    ds_read_b128 v[60:63], v17
    v_exp_f32 v209, v209
    v_exp_f32 v210, v210
    v_mfma_f32_32x32x16_bf16 v[144:159], v[68:71], v[84:87], v[144:159]
    ds_read_b128 v[64:67], v18
    v_exp_f32 v211, v211
    v_exp_f32 v212, v212
    v_cvt_pk_bf16_f32 v80, v208, v209
    v_mfma_f32_32x32x16_bf16 v[160:175], v[72:75], v[84:87], v[160:175]
    ds_read_b128 v[68:71], v19
    v_exp_f32 v213, v213
    v_exp_f32 v214, v214
    v_cvt_pk_bf16_f32 v81, v210, v211
    v_mfma_f32_32x32x16_bf16 v[176:191], v[76:79], v[84:87], v[176:191]
    ds_read_b128 v[72:75], v20
    v_exp_f32 v215, v215
    v_cvt_pk_bf16_f32 v82, v212, v213
    v_add_f32 v36, v36, v208
    s_waitcnt lgkmcnt(3)
    v_mfma_f32_32x32x16_bf16 v[192:207], v[48:51], v[92:95], 0
    ds_read_b128 v[76:79], v21
    v_exp_f32 v216, v216
    v_exp_f32 v217, v217
    v_cvt_pk_bf16_f32 v83, v214, v215
    v_mfma_f32_32x32x16_bf16 v[192:207], v[52:55], v[96:99], v[192:207]
    ds_read_b64_tr_b16 v[48:49], v22 offset:24576
    ds_read_b64_tr_b16 v[50:51], v22 offset:26624
    v_exp_f32 v218, v218
    v_cvt_pk_bf16_f32 v84, v216, v217
    v_mfma_f32_32x32x16_bf16 v[192:207], v[56:59], v[100:103], v[192:207]
    ds_read_b64_tr_b16 v[52:53], v23 offset:24576
    ds_read_b64_tr_b16 v[54:55], v23 offset:26624
    v_exp_f32 v219, v219
    v_add_f32 v37, v37, v209
    v_add_f32 v36, v36, v210
    v_mfma_f32_32x32x16_bf16 v[192:207], v[60:63], v[104:107], v[192:207]
    ds_read_b64_tr_b16 v[56:57], v24 offset:24576
    ds_read_b64_tr_b16 v[58:59], v24 offset:26624
    v_exp_f32 v220, v220
    v_cvt_pk_bf16_f32 v85, v218, v219
    s_waitcnt lgkmcnt(6)
    v_mfma_f32_32x32x16_bf16 v[192:207], v[64:67], v[108:111], v[192:207]
    ds_read_b64_tr_b16 v[60:61], v25 offset:24576
    ds_read_b64_tr_b16 v[62:63], v25 offset:26624
    v_exp_f32 v221, v221
    v_add_f32 v37, v37, v211
    v_add_f32 v36, v36, v212
    v_mfma_f32_32x32x16_bf16 v[192:207], v[68:71], v[112:115], v[192:207]
    ds_read_b64_tr_b16 v[64:65], v22 offset:28672
    ds_read_b64_tr_b16 v[66:67], v22 offset:30720
    v_exp_f32 v222, v222
    v_cvt_pk_bf16_f32 v86, v220, v221
    v_add_f32 v37, v37, v213
    v_mfma_f32_32x32x16_bf16 v[192:207], v[72:75], v[116:119], v[192:207]
    ds_read_b64_tr_b16 v[68:69], v23 offset:28672
    ds_read_b64_tr_b16 v[70:71], v23 offset:30720
    v_exp_f32 v223, v223
    v_add_f32 v36, v36, v214
    v_add_f32 v37, v37, v215
    v_mfma_f32_32x32x16_bf16 v[192:207], v[76:79], v[120:123], v[192:207]
    ds_read_b64_tr_b16 v[72:73], v24 offset:28672
    ds_read_b64_tr_b16 v[74:75], v24 offset:30720
    v_cvt_pk_bf16_f32 v87, v222, v223
    v_add_f32 v36, v36, v216
    s_waitcnt lgkmcnt(6)
    v_mfma_f32_32x32x16_bf16 v[128:143], v[48:51], v[80:83], v[128:143]
    ds_read_b64_tr_b16 v[76:77], v25 offset:28672
    ds_read_b64_tr_b16 v[78:79], v25 offset:30720
    v_add_f32 v37, v37, v217
    v_add_f32 v36, v36, v218
    v_add_f32 v37, v37, v219
    v_mfma_f32_32x32x16_bf16 v[144:159], v[52:55], v[80:83], v[144:159]
    s_barrier
    ds_read_b128 v[48:51], v14 offset:8192
    v_add_f32 v36, v36, v220
    v_add_f32 v37, v37, v221
    v_mfma_f32_32x32x16_bf16 v[160:175], v[56:59], v[80:83], v[160:175]
    ds_read_b128 v[52:55], v15 offset:8192
    v_add_f32 v36, v36, v222
    v_add_f32 v37, v37, v223
    v_mfma_f32_32x32x16_bf16 v[176:191], v[60:63], v[80:83], v[176:191]
    ds_read_b128 v[56:59], v16 offset:8192
    v_exp_f32 v192, v192
    s_waitcnt lgkmcnt(3)
    v_mfma_f32_32x32x16_bf16 v[128:143], v[64:67], v[84:87], v[128:143]
    ds_read_b128 v[60:63], v17 offset:8192
    v_exp_f32 v193, v193
    v_exp_f32 v194, v194
    v_mfma_f32_32x32x16_bf16 v[144:159], v[68:71], v[84:87], v[144:159]
    ds_read_b128 v[64:67], v18 offset:8192
    v_exp_f32 v195, v195
    v_exp_f32 v196, v196
    v_cvt_pk_bf16_f32 v80, v192, v193
    v_mfma_f32_32x32x16_bf16 v[160:175], v[72:75], v[84:87], v[160:175]
    ds_read_b128 v[68:71], v19 offset:8192
    v_exp_f32 v197, v197
    v_exp_f32 v198, v198
    v_cvt_pk_bf16_f32 v81, v194, v195
    v_mfma_f32_32x32x16_bf16 v[176:191], v[76:79], v[84:87], v[176:191]
    ds_read_b128 v[72:75], v20 offset:8192
    v_exp_f32 v199, v199
    v_cvt_pk_bf16_f32 v82, v196, v197
    v_add_f32 v36, v36, v192
    s_waitcnt lgkmcnt(3)
    v_mfma_f32_32x32x16_bf16 v[208:223], v[48:51], v[92:95], 0
    ds_read_b128 v[76:79], v21 offset:8192
    v_exp_f32 v200, v200
    v_exp_f32 v201, v201
    v_cvt_pk_bf16_f32 v83, v198, v199
    v_mfma_f32_32x32x16_bf16 v[208:223], v[52:55], v[96:99], v[208:223]
    ds_read_b64_tr_b16 v[48:49], v22
    ds_read_b64_tr_b16 v[50:51], v22 offset:2048
    v_exp_f32 v202, v202
    v_cvt_pk_bf16_f32 v84, v200, v201
    v_mfma_f32_32x32x16_bf16 v[208:223], v[56:59], v[100:103], v[208:223]
    ds_read_b64_tr_b16 v[52:53], v23
    ds_read_b64_tr_b16 v[54:55], v23 offset:2048
    v_exp_f32 v203, v203
    v_add_f32 v37, v37, v193
    v_add_f32 v36, v36, v194
    v_mfma_f32_32x32x16_bf16 v[208:223], v[60:63], v[104:107], v[208:223]
    ds_read_b64_tr_b16 v[56:57], v24
    ds_read_b64_tr_b16 v[58:59], v24 offset:2048
    v_exp_f32 v204, v204
    v_cvt_pk_bf16_f32 v85, v202, v203
    s_waitcnt lgkmcnt(6)
    v_mfma_f32_32x32x16_bf16 v[208:223], v[64:67], v[108:111], v[208:223]
    ds_read_b64_tr_b16 v[60:61], v25
    ds_read_b64_tr_b16 v[62:63], v25 offset:2048
    v_exp_f32 v205, v205
    v_add_f32 v37, v37, v195
    v_add_f32 v36, v36, v196
    v_mfma_f32_32x32x16_bf16 v[208:223], v[68:71], v[112:115], v[208:223]
    ds_read_b64_tr_b16 v[64:65], v22 offset:4096
    ds_read_b64_tr_b16 v[66:67], v22 offset:6144
    v_exp_f32 v206, v206
    v_cvt_pk_bf16_f32 v86, v204, v205
    v_add_f32 v37, v37, v197
    v_mfma_f32_32x32x16_bf16 v[208:223], v[72:75], v[116:119], v[208:223]
    ds_read_b64_tr_b16 v[68:69], v23 offset:4096
    ds_read_b64_tr_b16 v[70:71], v23 offset:6144
    v_exp_f32 v207, v207
    v_add_f32 v36, v36, v198
    v_add_f32 v37, v37, v199
    v_mfma_f32_32x32x16_bf16 v[208:223], v[76:79], v[120:123], v[208:223]
    ds_read_b64_tr_b16 v[72:73], v24 offset:4096
    ds_read_b64_tr_b16 v[74:75], v24 offset:6144
    v_cvt_pk_bf16_f32 v87, v206, v207
    v_add_f32 v36, v36, v200
    s_waitcnt lgkmcnt(6)
    v_mfma_f32_32x32x16_bf16 v[128:143], v[48:51], v[80:83], v[128:143]
    ds_read_b64_tr_b16 v[76:77], v25 offset:4096
    ds_read_b64_tr_b16 v[78:79], v25 offset:6144
    v_add_f32 v37, v37, v201
    v_add_f32 v36, v36, v202
    v_add_f32 v37, v37, v203
    v_mfma_f32_32x32x16_bf16 v[144:159], v[52:55], v[80:83], v[144:159]
    s_barrier
    ds_read_b128 v[48:51], v14 offset:16384
    v_add_f32 v36, v36, v204
    v_add_f32 v37, v37, v205
    v_mfma_f32_32x32x16_bf16 v[160:175], v[56:59], v[80:83], v[160:175]
    ds_read_b128 v[52:55], v15 offset:16384
    v_add_f32 v36, v36, v206
    v_add_f32 v37, v37, v207
    v_mfma_f32_32x32x16_bf16 v[176:191], v[60:63], v[80:83], v[176:191]
    ds_read_b128 v[56:59], v16 offset:16384
    v_exp_f32 v208, v208
    s_waitcnt lgkmcnt(3)
    v_mfma_f32_32x32x16_bf16 v[128:143], v[64:67], v[84:87], v[128:143]
    ds_read_b128 v[60:63], v17 offset:16384
    v_exp_f32 v209, v209
    v_exp_f32 v210, v210
    v_mfma_f32_32x32x16_bf16 v[144:159], v[68:71], v[84:87], v[144:159]
    ds_read_b128 v[64:67], v18 offset:16384
    v_exp_f32 v211, v211
    v_exp_f32 v212, v212
    v_cvt_pk_bf16_f32 v80, v208, v209
    v_mfma_f32_32x32x16_bf16 v[160:175], v[72:75], v[84:87], v[160:175]
    ds_read_b128 v[68:71], v19 offset:16384
    v_exp_f32 v213, v213
    v_exp_f32 v214, v214
    v_cvt_pk_bf16_f32 v81, v210, v211
    v_mfma_f32_32x32x16_bf16 v[176:191], v[76:79], v[84:87], v[176:191]
    ds_read_b128 v[72:75], v20 offset:16384
    v_exp_f32 v215, v215
    v_cvt_pk_bf16_f32 v82, v212, v213
    v_add_f32 v36, v36, v208
    s_waitcnt lgkmcnt(3)
    v_mfma_f32_32x32x16_bf16 v[192:207], v[48:51], v[92:95], 0
    ds_read_b128 v[76:79], v21 offset:16384
    v_exp_f32 v216, v216
    v_exp_f32 v217, v217
    v_cvt_pk_bf16_f32 v83, v214, v215
    v_mfma_f32_32x32x16_bf16 v[192:207], v[52:55], v[96:99], v[192:207]
    ds_read_b64_tr_b16 v[48:49], v22 offset:8192
    ds_read_b64_tr_b16 v[50:51], v22 offset:10240
    v_exp_f32 v218, v218
    v_cvt_pk_bf16_f32 v84, v216, v217
    v_mfma_f32_32x32x16_bf16 v[192:207], v[56:59], v[100:103], v[192:207]
    ds_read_b64_tr_b16 v[52:53], v23 offset:8192
    ds_read_b64_tr_b16 v[54:55], v23 offset:10240
    v_exp_f32 v219, v219
    v_add_f32 v37, v37, v209
    v_add_f32 v36, v36, v210
    v_mfma_f32_32x32x16_bf16 v[192:207], v[60:63], v[104:107], v[192:207]
    ds_read_b64_tr_b16 v[56:57], v24 offset:8192
    ds_read_b64_tr_b16 v[58:59], v24 offset:10240
    v_exp_f32 v220, v220
    v_cvt_pk_bf16_f32 v85, v218, v219
    s_waitcnt lgkmcnt(6)
    v_mfma_f32_32x32x16_bf16 v[192:207], v[64:67], v[108:111], v[192:207]
    ds_read_b64_tr_b16 v[60:61], v25 offset:8192
    ds_read_b64_tr_b16 v[62:63], v25 offset:10240
    v_exp_f32 v221, v221
    v_add_f32 v37, v37, v211
    v_add_f32 v36, v36, v212
    v_mfma_f32_32x32x16_bf16 v[192:207], v[68:71], v[112:115], v[192:207]
    ds_read_b64_tr_b16 v[64:65], v22 offset:12288
    ds_read_b64_tr_b16 v[66:67], v22 offset:14336
    v_exp_f32 v222, v222
    v_cvt_pk_bf16_f32 v86, v220, v221
    v_add_f32 v37, v37, v213
    v_mfma_f32_32x32x16_bf16 v[192:207], v[72:75], v[116:119], v[192:207]
    ds_read_b64_tr_b16 v[68:69], v23 offset:12288
    ds_read_b64_tr_b16 v[70:71], v23 offset:14336
    v_exp_f32 v223, v223
    v_add_f32 v36, v36, v214
    v_add_f32 v37, v37, v215
    v_mfma_f32_32x32x16_bf16 v[192:207], v[76:79], v[120:123], v[192:207]
    ds_read_b64_tr_b16 v[72:73], v24 offset:12288
    ds_read_b64_tr_b16 v[74:75], v24 offset:14336
    v_cvt_pk_bf16_f32 v87, v222, v223
    v_add_f32 v36, v36, v216
    s_waitcnt lgkmcnt(6)
    v_mfma_f32_32x32x16_bf16 v[128:143], v[48:51], v[80:83], v[128:143]
    ds_read_b64_tr_b16 v[76:77], v25 offset:12288
    ds_read_b64_tr_b16 v[78:79], v25 offset:14336
    v_add_f32 v37, v37, v217
    v_add_f32 v36, v36, v218
    v_add_f32 v37, v37, v219
    v_mfma_f32_32x32x16_bf16 v[144:159], v[52:55], v[80:83], v[144:159]
    s_barrier
    ds_read_b128 v[48:51], v14 offset:24576
    v_add_f32 v36, v36, v220
    v_add_f32 v37, v37, v221
    v_mfma_f32_32x32x16_bf16 v[160:175], v[56:59], v[80:83], v[160:175]
    ds_read_b128 v[52:55], v15 offset:24576
    v_add_f32 v36, v36, v222
    v_add_f32 v37, v37, v223
    v_mfma_f32_32x32x16_bf16 v[176:191], v[60:63], v[80:83], v[176:191]
    ds_read_b128 v[56:59], v16 offset:24576
    v_exp_f32 v192, v192
    s_waitcnt lgkmcnt(3)
    v_mfma_f32_32x32x16_bf16 v[128:143], v[64:67], v[84:87], v[128:143]
    ds_read_b128 v[60:63], v17 offset:24576
    v_exp_f32 v193, v193
    v_exp_f32 v194, v194
    v_mfma_f32_32x32x16_bf16 v[144:159], v[68:71], v[84:87], v[144:159]
    ds_read_b128 v[64:67], v18 offset:24576
    v_exp_f32 v195, v195
    v_exp_f32 v196, v196
    v_cvt_pk_bf16_f32 v80, v192, v193
    v_mfma_f32_32x32x16_bf16 v[160:175], v[72:75], v[84:87], v[160:175]
    ds_read_b128 v[68:71], v19 offset:24576
    v_exp_f32 v197, v197
    v_exp_f32 v198, v198
    v_cvt_pk_bf16_f32 v81, v194, v195
    v_mfma_f32_32x32x16_bf16 v[176:191], v[76:79], v[84:87], v[176:191]
    ds_read_b128 v[72:75], v20 offset:24576
    v_exp_f32 v199, v199
    v_cvt_pk_bf16_f32 v82, v196, v197
    v_add_f32 v36, v36, v192
    s_waitcnt lgkmcnt(3)
    v_mfma_f32_32x32x16_bf16 v[208:223], v[48:51], v[92:95], 0
    ds_read_b128 v[76:79], v21 offset:24576
    v_exp_f32 v200, v200
    v_exp_f32 v201, v201
    v_cvt_pk_bf16_f32 v83, v198, v199
    v_mfma_f32_32x32x16_bf16 v[208:223], v[52:55], v[96:99], v[208:223]
    ds_read_b64_tr_b16 v[48:49], v22 offset:16384
    ds_read_b64_tr_b16 v[50:51], v22 offset:18432
    v_exp_f32 v202, v202
    v_cvt_pk_bf16_f32 v84, v200, v201
    v_mfma_f32_32x32x16_bf16 v[208:223], v[56:59], v[100:103], v[208:223]
    ds_read_b64_tr_b16 v[52:53], v23 offset:16384
    ds_read_b64_tr_b16 v[54:55], v23 offset:18432
    v_exp_f32 v203, v203
    v_add_f32 v37, v37, v193
    v_add_f32 v36, v36, v194
    v_mfma_f32_32x32x16_bf16 v[208:223], v[60:63], v[104:107], v[208:223]
    ds_read_b64_tr_b16 v[56:57], v24 offset:16384
    ds_read_b64_tr_b16 v[58:59], v24 offset:18432
    v_exp_f32 v204, v204
    v_cvt_pk_bf16_f32 v85, v202, v203
    s_waitcnt lgkmcnt(6)
    v_mfma_f32_32x32x16_bf16 v[208:223], v[64:67], v[108:111], v[208:223]
    ds_read_b64_tr_b16 v[60:61], v25 offset:16384
    ds_read_b64_tr_b16 v[62:63], v25 offset:18432
    v_exp_f32 v205, v205
    v_add_f32 v37, v37, v195
    v_add_f32 v36, v36, v196
    v_mfma_f32_32x32x16_bf16 v[208:223], v[68:71], v[112:115], v[208:223]
    ds_read_b64_tr_b16 v[64:65], v22 offset:20480
    ds_read_b64_tr_b16 v[66:67], v22 offset:22528
    v_exp_f32 v206, v206
    v_cvt_pk_bf16_f32 v86, v204, v205
    v_add_f32 v37, v37, v197
    v_mfma_f32_32x32x16_bf16 v[208:223], v[72:75], v[116:119], v[208:223]
    ds_read_b64_tr_b16 v[68:69], v23 offset:20480
    ds_read_b64_tr_b16 v[70:71], v23 offset:22528
L_mk5:
    s_cbranch_execz L_rt5
    v_exp_f32 v207, v207
    v_add_f32 v36, v36, v198
    v_add_f32 v37, v37, v199
    v_mfma_f32_32x32x16_bf16 v[208:223], v[76:79], v[120:123], v[208:223]
    ds_read_b64_tr_b16 v[72:73], v24 offset:20480
    ds_read_b64_tr_b16 v[74:75], v24 offset:22528
    v_cvt_pk_bf16_f32 v87, v206, v207
    v_add_f32 v36, v36, v200
    s_waitcnt lgkmcnt(6)
    v_mfma_f32_32x32x16_bf16 v[128:143], v[48:51], v[80:83], v[128:143]
    ds_read_b64_tr_b16 v[76:77], v25 offset:20480
    ds_read_b64_tr_b16 v[78:79], v25 offset:22528
    v_add_f32 v37, v37, v201
    v_add_f32 v36, v36, v202
    v_add_f32 v37, v37, v203
    v_mfma_f32_32x32x16_bf16 v[144:159], v[52:55], v[80:83], v[144:159]
    s_barrier
    ds_read_b64_tr_b16 v[48:49], v22 offset:24576
    ds_read_b64_tr_b16 v[50:51], v22 offset:26624
    v_add_f32 v36, v36, v204
    v_add_f32 v37, v37, v205
    v_mfma_f32_32x32x16_bf16 v[160:175], v[56:59], v[80:83], v[160:175]
    ds_read_b64_tr_b16 v[52:53], v23 offset:24576
    ds_read_b64_tr_b16 v[54:55], v23 offset:26624
    v_add_f32 v36, v36, v206
    v_add_f32 v37, v37, v207
    v_mfma_f32_32x32x16_bf16 v[176:191], v[60:63], v[80:83], v[176:191]
    ds_read_b64_tr_b16 v[56:57], v24 offset:24576
    ds_read_b64_tr_b16 v[58:59], v24 offset:26624
    v_exp_f32 v208, v208
    s_waitcnt lgkmcnt(6)
    v_mfma_f32_32x32x16_bf16 v[128:143], v[64:67], v[84:87], v[128:143]
    ds_read_b64_tr_b16 v[60:61], v25 offset:24576
    ds_read_b64_tr_b16 v[62:63], v25 offset:26624
    v_exp_f32 v209, v209
    v_exp_f32 v210, v210
    v_mfma_f32_32x32x16_bf16 v[144:159], v[68:71], v[84:87], v[144:159]
    ds_read_b64_tr_b16 v[64:65], v22 offset:28672
    ds_read_b64_tr_b16 v[66:67], v22 offset:30720
    v_exp_f32 v211, v211
    v_exp_f32 v212, v212
    v_cvt_pk_bf16_f32 v80, v208, v209
    v_mfma_f32_32x32x16_bf16 v[160:175], v[72:75], v[84:87], v[160:175]
    ds_read_b64_tr_b16 v[68:69], v23 offset:28672
    ds_read_b64_tr_b16 v[70:71], v23 offset:30720
    v_exp_f32 v213, v213
    v_exp_f32 v214, v214
    v_cvt_pk_bf16_f32 v81, v210, v211
    v_mfma_f32_32x32x16_bf16 v[176:191], v[76:79], v[84:87], v[176:191]
    ds_read_b64_tr_b16 v[72:73], v24 offset:28672
    ds_read_b64_tr_b16 v[74:75], v24 offset:30720
    v_exp_f32 v215, v215
    v_cvt_pk_bf16_f32 v82, v212, v213
    v_add_f32 v36, v36, v208
    v_cvt_pk_bf16_f32 v83, v214, v215
    s_waitcnt lgkmcnt(6)
    s_nop 0
    v_mfma_f32_32x32x16_bf16 v[128:143], v[48:51], v[80:83], v[128:143]
    ds_read_b64_tr_b16 v[76:77], v25 offset:28672
    ds_read_b64_tr_b16 v[78:79], v25 offset:30720
    v_exp_f32 v216, v216
    v_exp_f32 v217, v217
    v_add_f32 v37, v37, v209
    v_mfma_f32_32x32x16_bf16 v[144:159], v[52:55], v[80:83], v[144:159]
    v_exp_f32 v218, v218
    v_exp_f32 v219, v219
    v_cvt_pk_bf16_f32 v84, v216, v217
    v_add_f32 v36, v36, v210
    v_mfma_f32_32x32x16_bf16 v[160:175], v[56:59], v[80:83], v[160:175]
    v_exp_f32 v220, v220
    v_exp_f32 v221, v221
    v_cvt_pk_bf16_f32 v85, v218, v219
    v_add_f32 v37, v37, v211
    v_mfma_f32_32x32x16_bf16 v[176:191], v[60:63], v[80:83], v[176:191]
    v_exp_f32 v222, v222
    v_exp_f32 v223, v223
    v_cvt_pk_bf16_f32 v86, v220, v221
    v_cvt_pk_bf16_f32 v87, v222, v223
    v_add_f32 v36, v36, v212
    s_waitcnt lgkmcnt(0)
    v_mfma_f32_32x32x16_bf16 v[128:143], v[64:67], v[84:87], v[128:143]
    v_add_f32 v37, v37, v213
    v_add_f32 v36, v36, v214
    v_add_f32 v37, v37, v215
    v_add_f32 v36, v36, v216
    v_add_f32 v37, v37, v217
    v_add_f32 v36, v36, v218
    v_mfma_f32_32x32x16_bf16 v[144:159], v[68:71], v[84:87], v[144:159]
    v_add_f32 v37, v37, v219
    v_add_f32 v36, v36, v220
    v_add_f32 v37, v37, v221
    v_add_f32 v36, v36, v222
    v_add_f32 v37, v37, v223
    v_mfma_f32_32x32x16_bf16 v[160:175], v[72:75], v[84:87], v[160:175]
    v_add_f32 v36, v36, v37
    v_mov_b32 v38, v36
    s_mov_b32 s43, 0x33800000
    s_mov_b32 s44, 0x4b800000
    v_permlane32_swap_b32 v36, v38
    v_add_f32 v36, v36, v38
    v_rcp_f32 v41, v36
    v_cmp_nle_f32 vcc, s43, v36
    v_cmp_nge_f32 s[56:57], s44, v36
    v_mfma_f32_32x32x16_bf16 v[176:191], v[76:79], v[84:87], v[176:191]
    s_waitcnt lgkmcnt(0)
    s_barrier
L_norm:
    ds_read_b64_tr_b16 v[48:49], v26
    ds_read_b64_tr_b16 v[50:51], v26 offset:1024
    ds_read_b64_tr_b16 v[52:53], v26 offset:2048
    ds_read_b64_tr_b16 v[54:55], v26 offset:3072
    ds_read_b64_tr_b16 v[56:57], v26 offset:4096
    ds_read_b64_tr_b16 v[58:59], v26 offset:5120
    ds_read_b64_tr_b16 v[60:61], v26 offset:6144
    ds_read_b64_tr_b16 v[62:63], v26 offset:7168
    v_pk_mul_f32 v[128:129], v[128:129], v[40:41] op_sel:[0,1] op_sel_hi:[1,1]
    v_pk_mul_f32 v[130:131], v[130:131], v[40:41] op_sel:[0,1] op_sel_hi:[1,1]
    v_pk_mul_f32 v[132:133], v[132:133], v[40:41] op_sel:[0,1] op_sel_hi:[1,1]
    v_pk_mul_f32 v[134:135], v[134:135], v[40:41] op_sel:[0,1] op_sel_hi:[1,1]
    v_pk_mul_f32 v[136:137], v[136:137], v[40:41] op_sel:[0,1] op_sel_hi:[1,1]
    v_pk_mul_f32 v[138:139], v[138:139], v[40:41] op_sel:[0,1] op_sel_hi:[1,1]
    v_pk_mul_f32 v[140:141], v[140:141], v[40:41] op_sel:[0,1] op_sel_hi:[1,1]
    v_pk_mul_f32 v[142:143], v[142:143], v[40:41] op_sel:[0,1] op_sel_hi:[1,1]
    v_cvt_pk_bf16_f32 v192, v128, v129
    v_cvt_pk_bf16_f32 v193, v130, v131
    v_cvt_pk_bf16_f32 v194, v132, v133
    v_cvt_pk_bf16_f32 v195, v134, v135
    v_cvt_pk_bf16_f32 v196, v136, v137
    v_cvt_pk_bf16_f32 v197, v138, v139
    v_cvt_pk_bf16_f32 v198, v140, v141
    v_cvt_pk_bf16_f32 v199, v142, v143
    s_or_b64 vcc, vcc, s[56:57]
    s_cmp_lg_u32 s53, 0
    s_cbranch_scc1 L_novote
    s_cbranch_vccz L_novote
    v_mov_b32 v192, -1
L_novote:
    ds_read_b64_tr_b16 v[64:65], v26 offset:8192
    ds_read_b64_tr_b16 v[66:67], v26 offset:9216
    ds_read_b64_tr_b16 v[68:69], v26 offset:10240
    ds_read_b64_tr_b16 v[70:71], v26 offset:11264
    ds_read_b64_tr_b16 v[72:73], v26 offset:12288
    ds_read_b64_tr_b16 v[74:75], v26 offset:13312
    s_waitcnt lgkmcnt(6)
    v_mfma_f32_32x32x16_bf16 v[224:239], v[48:51], v[192:195], 0
    ds_read_b64_tr_b16 v[76:77], v26 offset:14336
    ds_read_b64_tr_b16 v[78:79], v26 offset:15360
    ds_write_b128 v34, v[192:195]
    v_mul_f32 v144, v41, v144
    v_mul_f32 v145, v41, v145
    v_mul_f32 v146, v41, v146
    v_mul_f32 v147, v41, v147
    v_mul_f32 v148, v41, v148
    v_mul_f32 v149, v41, v149
    v_mul_f32 v150, v41, v150
    v_mul_f32 v151, v41, v151
    v_mul_f32 v152, v41, v152
    v_mul_f32 v153, v41, v153
    v_mul_f32 v154, v41, v154
    v_mul_f32 v155, v41, v155
    v_mfma_f32_32x32x16_bf16 v[224:239], v[52:55], v[196:199], v[224:239]
    ds_read_b64_tr_b16 v[48:49], v26 offset:32768
    ds_read_b64_tr_b16 v[50:51], v26 offset:33792
    ds_write_b128 v34, v[196:199] offset:1024
    v_mul_f32 v156, v41, v156
    v_mul_f32 v157, v41, v157
    v_mul_f32 v158, v41, v158
    v_mul_f32 v159, v41, v159
    v_cvt_pk_bf16_f32 v200, v144, v145
    v_cvt_pk_bf16_f32 v201, v146, v147
    v_cvt_pk_bf16_f32 v202, v148, v149
    v_cvt_pk_bf16_f32 v203, v150, v151
    v_cvt_pk_bf16_f32 v204, v152, v153
    v_cvt_pk_bf16_f32 v205, v154, v155
    v_cvt_pk_bf16_f32 v206, v156, v157
    v_cvt_pk_bf16_f32 v207, v158, v159
    v_mfma_f32_32x32x16_bf16 v[224:239], v[56:59], v[200:203], v[224:239]
    ds_read_b64_tr_b16 v[52:53], v26 offset:34816
    ds_read_b64_tr_b16 v[54:55], v26 offset:35840
    ds_write_b128 v34, v[200:203] offset:2048
    v_mul_f32 v160, v41, v160
    v_mul_f32 v161, v41, v161
    v_mul_f32 v162, v41, v162
    v_mul_f32 v163, v41, v163
    v_mul_f32 v164, v41, v164
    v_mul_f32 v165, v41, v165
    v_mul_f32 v166, v41, v166
    v_mul_f32 v167, v41, v167
    v_mul_f32 v168, v41, v168
    v_mul_f32 v169, v41, v169
    v_mul_f32 v170, v41, v170
    v_mul_f32 v171, v41, v171
    v_mfma_f32_32x32x16_bf16 v[224:239], v[60:63], v[204:207], v[224:239]
    s_waitcnt lgkmcnt(14)
    ds_read_b64_tr_b16 v[56:57], v26 offset:36864
    s_waitcnt lgkmcnt(14)
    ds_read_b64_tr_b16 v[58:59], v26 offset:37888
    s_waitcnt lgkmcnt(13)
    ds_write_b128 v34, v[204:207] offset:3072
    v_mul_f32 v172, v41, v172
    v_mul_f32 v173, v41, v173
    v_mul_f32 v174, v41, v174
    v_mul_f32 v175, v41, v175
    v_cvt_pk_bf16_f32 v208, v160, v161
    v_cvt_pk_bf16_f32 v209, v162, v163
    v_cvt_pk_bf16_f32 v210, v164, v165
    v_cvt_pk_bf16_f32 v211, v166, v167
    v_cvt_pk_bf16_f32 v212, v168, v169
    v_cvt_pk_bf16_f32 v213, v170, v171
    v_cvt_pk_bf16_f32 v214, v172, v173
    v_cvt_pk_bf16_f32 v215, v174, v175
    s_waitcnt lgkmcnt(10)
    v_mfma_f32_32x32x16_bf16 v[224:239], v[64:67], v[208:211], v[224:239]
    ds_read_b64_tr_b16 v[60:61], v26 offset:38912
    ds_read_b64_tr_b16 v[62:63], v26 offset:39936
    ds_write_b128 v34, v[208:211] offset:4096
    v_mul_f32 v176, v41, v176
    v_mul_f32 v177, v41, v177
    v_mul_f32 v178, v41, v178
    v_mul_f32 v179, v41, v179
    v_mul_f32 v180, v41, v180
    v_mul_f32 v181, v41, v181
    v_mul_f32 v182, v41, v182
    v_mul_f32 v183, v41, v183
    v_mul_f32 v184, v41, v184
    v_mul_f32 v185, v41, v185
    v_mul_f32 v186, v41, v186
    v_mul_f32 v187, v41, v187
    v_mfma_f32_32x32x16_bf16 v[224:239], v[68:71], v[212:215], v[224:239]
    ds_read_b64_tr_b16 v[64:65], v26 offset:40960
    ds_read_b64_tr_b16 v[66:67], v26 offset:41984
    s_waitcnt lgkmcnt(13)
    ds_write_b128 v34, v[212:215] offset:5120
    v_mul_f32 v188, v41, v188
    v_mul_f32 v189, v41, v189
    v_mul_f32 v190, v41, v190
    v_mul_f32 v191, v41, v191
    v_cvt_pk_bf16_f32 v216, v176, v177
    v_cvt_pk_bf16_f32 v217, v178, v179
    v_cvt_pk_bf16_f32 v218, v180, v181
    v_cvt_pk_bf16_f32 v219, v182, v183
    v_cvt_pk_bf16_f32 v220, v184, v185
    v_cvt_pk_bf16_f32 v221, v186, v187
    v_cvt_pk_bf16_f32 v222, v188, v189
    v_cvt_pk_bf16_f32 v223, v190, v191
    v_mfma_f32_32x32x16_bf16 v[224:239], v[72:75], v[216:219], v[224:239]
    ds_read_b64_tr_b16 v[68:69], v26 offset:43008
    s_waitcnt lgkmcnt(14)
    ds_read_b64_tr_b16 v[70:71], v26 offset:44032
    s_waitcnt lgkmcnt(13)
    ds_write_b128 v34, v[216:219] offset:6144
    v_mfma_f32_32x32x16_bf16 v[224:239], v[76:79], v[220:223], v[224:239]
    ds_read_b64_tr_b16 v[72:73], v26 offset:45056
    s_waitcnt lgkmcnt(14)
    ds_read_b64_tr_b16 v[74:75], v26 offset:46080
    s_waitcnt lgkmcnt(13)
    ds_write_b128 v34, v[220:223] offset:7168
    s_waitcnt lgkmcnt(10)
    v_mfma_f32_32x32x16_bf16 v[160:175], v[48:51], v[192:195], 0
    ds_read_b64_tr_b16 v[76:77], v26 offset:47104
    ds_read_b64_tr_b16 v[78:79], v26 offset:48128
    v_mfma_f32_32x32x16_bf16 v[160:175], v[52:55], v[196:199], v[160:175]
    v_and_b32 v38, 3, v1
    v_lshlrev_b32 v38, 13, v38
    v_add_u32 v38, 131072, v38
    s_waitcnt lgkmcnt(2)
    s_barrier
    ds_read_b32 v39, v38
    ds_read_b64_tr_b16 v[48:49], v27
    ds_read_b64_tr_b16 v[50:51], v27 offset:1024
    ds_read_b128 v[128:131], v35
    ds_read_b128 v[132:135], v35 offset:1024
    v_mfma_f32_32x32x16_bf16 v[160:175], v[56:59], v[200:203], v[160:175]
    ds_read_b64_tr_b16 v[52:53], v27 offset:2048
    ds_read_b64_tr_b16 v[54:55], v27 offset:3072
    ds_read_b128 v[136:139], v35 offset:2048
    ds_read_b128 v[140:143], v35 offset:3072
    v_mfma_f32_32x32x16_bf16 v[160:175], v[60:63], v[204:207], v[160:175]
    ds_read_b64_tr_b16 v[56:57], v27 offset:4096
    ds_read_b64_tr_b16 v[58:59], v27 offset:5120
    ds_read_b128 v[144:147], v35 offset:4096
    ds_read_b128 v[148:151], v35 offset:5120
    s_waitcnt lgkmcnt(13)
    v_mfma_f32_32x32x16_bf16 v[160:175], v[64:67], v[208:211], v[160:175]
    s_waitcnt lgkmcnt(12)
    v_cmp_eq_u32 vcc, -1, v39
    s_cmp_lg_u32 s53, 0
    s_cbranch_scc1 L_voted
    s_cbranch_vccnz L_slow
L_voted:
    ds_read_b64_tr_b16 v[60:61], v27 offset:6144
    ds_read_b64_tr_b16 v[62:63], v27 offset:7168
    ds_read_b128 v[152:155], v35 offset:6144
    s_waitcnt lgkmcnt(14)
    ds_read_b128 v[156:159], v35 offset:7168
    v_mfma_f32_32x32x16_bf16 v[160:175], v[68:71], v[212:215], v[160:175]
    s_waitcnt lgkmcnt(14)
    ds_read_b64_tr_b16 v[64:65], v27 offset:8192
    s_waitcnt lgkmcnt(14)
    ds_read_b64_tr_b16 v[66:67], v27 offset:9216
    v_mfma_f32_32x32x16_bf16 v[160:175], v[72:75], v[216:219], v[160:175]
    s_waitcnt lgkmcnt(14)
    ds_read_b64_tr_b16 v[68:69], v27 offset:10240
    s_waitcnt lgkmcnt(14)
    ds_read_b64_tr_b16 v[70:71], v27 offset:11264
    v_mfma_f32_32x32x16_bf16 v[160:175], v[76:79], v[220:223], v[160:175]
    s_waitcnt lgkmcnt(4)
    s_barrier
    ds_read_b64_tr_b16 v[72:73], v27 offset:12288
    ds_read_b64_tr_b16 v[74:75], v27 offset:13312
    v_mfma_f32_32x32x16_bf16 v[224:239], v[48:51], v[128:131], v[224:239]
    ds_read_b64_tr_b16 v[76:77], v27 offset:14336
    ds_read_b64_tr_b16 v[78:79], v27 offset:15360
    v_mfma_f32_32x32x16_bf16 v[224:239], v[52:55], v[132:135], v[224:239]
    ds_read_b64_tr_b16 v[48:49], v27 offset:32768
    ds_read_b64_tr_b16 v[50:51], v27 offset:33792
    v_mfma_f32_32x32x16_bf16 v[224:239], v[56:59], v[136:139], v[224:239]
    ds_read_b64_tr_b16 v[52:53], v27 offset:34816
    ds_read_b64_tr_b16 v[54:55], v27 offset:35840
    v_mfma_f32_32x32x16_bf16 v[224:239], v[60:63], v[140:143], v[224:239]
    ds_read_b64_tr_b16 v[56:57], v27 offset:36864
    ds_read_b64_tr_b16 v[58:59], v27 offset:37888
    s_waitcnt lgkmcnt(6)
    v_mfma_f32_32x32x16_bf16 v[224:239], v[64:67], v[144:147], v[224:239]
    ds_read_b64_tr_b16 v[60:61], v27 offset:38912
    ds_read_b64_tr_b16 v[62:63], v27 offset:39936
    v_mfma_f32_32x32x16_bf16 v[224:239], v[68:71], v[148:151], v[224:239]
    ds_read_b64_tr_b16 v[64:65], v27 offset:40960
    ds_read_b64_tr_b16 v[66:67], v27 offset:41984
    v_mfma_f32_32x32x16_bf16 v[224:239], v[72:75], v[152:155], v[224:239]
    ds_read_b64_tr_b16 v[68:69], v27 offset:43008
    ds_read_b64_tr_b16 v[70:71], v27 offset:44032
    v_mfma_f32_32x32x16_bf16 v[224:239], v[76:79], v[156:159], v[224:239]
    ds_read_b64_tr_b16 v[72:73], v27 offset:45056
    ds_read_b64_tr_b16 v[74:75], v27 offset:46080
    s_waitcnt lgkmcnt(6)
    v_mfma_f32_32x32x16_bf16 v[160:175], v[48:51], v[128:131], v[160:175]
    ds_read_b64_tr_b16 v[76:77], v27 offset:47104
    ds_read_b64_tr_b16 v[78:79], v27 offset:48128
    v_mfma_f32_32x32x16_bf16 v[160:175], v[52:55], v[132:135], v[160:175]
    s_barrier
    ds_read_b64_tr_b16 v[48:49], v28
    ds_read_b64_tr_b16 v[50:51], v28 offset:1024
    v_mfma_f32_32x32x16_bf16 v[160:175], v[56:59], v[136:139], v[160:175]
    ds_read_b64_tr_b16 v[52:53], v28 offset:2048
    ds_read_b64_tr_b16 v[54:55], v28 offset:3072
    s_add_u32 s43, s42, 0
    s_and_b32 s43, s43, 7
    s_lshl_b32 s44, s43, 17
    v_mfma_f32_32x32x16_bf16 v[160:175], v[60:63], v[140:143], v[160:175]
    ds_read_b64_tr_b16 v[56:57], v28 offset:4096
    ds_read_b64_tr_b16 v[58:59], v28 offset:5120
    v_cvt_pk_bf16_f32 v176, v224, v225
    v_cvt_pk_bf16_f32 v177, v226, v227
    s_waitcnt lgkmcnt(6)
    v_mfma_f32_32x32x16_bf16 v[160:175], v[64:67], v[144:147], v[160:175]
    ds_read_b64_tr_b16 v[60:61], v28 offset:6144
    ds_read_b64_tr_b16 v[62:63], v28 offset:7168
    v_cvt_pk_bf16_f32 v178, v228, v229
    v_cvt_pk_bf16_f32 v179, v230, v231
    v_mfma_f32_32x32x16_bf16 v[160:175], v[68:71], v[148:151], v[160:175]
    ds_read_b64_tr_b16 v[64:65], v28 offset:8192
    ds_read_b64_tr_b16 v[66:67], v28 offset:9216
    v_cvt_pk_bf16_f32 v180, v232, v233
    v_cvt_pk_bf16_f32 v181, v234, v235
    buffer_store_dwordx4 v[176:179], v32, s[28:31], s44 offen sc1
    v_mfma_f32_32x32x16_bf16 v[160:175], v[72:75], v[152:155], v[160:175]
    ds_read_b64_tr_b16 v[68:69], v28 offset:10240
    ds_read_b64_tr_b16 v[70:71], v28 offset:11264
    v_cvt_pk_bf16_f32 v182, v236, v237
    v_cvt_pk_bf16_f32 v183, v238, v239
    v_mfma_f32_32x32x16_bf16 v[160:175], v[76:79], v[156:159], v[160:175]
    ds_read_b64_tr_b16 v[72:73], v28 offset:12288
    ds_read_b64_tr_b16 v[74:75], v28 offset:13312
    buffer_store_dwordx4 v[180:183], v32, s[28:31], s44 offen offset:1024 sc1
    s_waitcnt lgkmcnt(6)
    v_mfma_f32_32x32x16_bf16 v[224:239], v[48:51], v[192:195], 0
    ds_read_b64_tr_b16 v[76:77], v28 offset:14336
    ds_read_b64_tr_b16 v[78:79], v28 offset:15360
    v_mfma_f32_32x32x16_bf16 v[224:239], v[52:55], v[196:199], v[224:239]
    ds_read_b64_tr_b16 v[48:49], v29
    ds_read_b64_tr_b16 v[50:51], v29 offset:1024
    v_mfma_f32_32x32x16_bf16 v[224:239], v[56:59], v[200:203], v[224:239]
    ds_read_b64_tr_b16 v[52:53], v29 offset:2048
    ds_read_b64_tr_b16 v[54:55], v29 offset:3072
    v_mfma_f32_32x32x16_bf16 v[224:239], v[60:63], v[204:207], v[224:239]
    ds_read_b64_tr_b16 v[56:57], v29 offset:4096
    ds_read_b64_tr_b16 v[58:59], v29 offset:5120
    s_waitcnt lgkmcnt(6)
    v_mfma_f32_32x32x16_bf16 v[224:239], v[64:67], v[208:211], v[224:239]
    ds_read_b64_tr_b16 v[60:61], v29 offset:6144
    ds_read_b64_tr_b16 v[62:63], v29 offset:7168
    v_mfma_f32_32x32x16_bf16 v[224:239], v[68:71], v[212:215], v[224:239]
    ds_read_b64_tr_b16 v[64:65], v29 offset:8192
    ds_read_b64_tr_b16 v[66:67], v29 offset:9216
    s_add_u32 s43, s42, 1
    s_and_b32 s43, s43, 7
    s_lshl_b32 s44, s43, 17
    s_add_u32 s44, s44, 8192
    v_mfma_f32_32x32x16_bf16 v[224:239], v[72:75], v[216:219], v[224:239]
    ds_read_b64_tr_b16 v[68:69], v29 offset:10240
    ds_read_b64_tr_b16 v[70:71], v29 offset:11264
    v_cvt_pk_bf16_f32 v184, v160, v161
    v_cvt_pk_bf16_f32 v185, v162, v163
    v_mfma_f32_32x32x16_bf16 v[224:239], v[76:79], v[220:223], v[224:239]
    ds_read_b64_tr_b16 v[72:73], v29 offset:12288
    ds_read_b64_tr_b16 v[74:75], v29 offset:13312
    v_cvt_pk_bf16_f32 v186, v164, v165
    v_cvt_pk_bf16_f32 v187, v166, v167
    s_waitcnt lgkmcnt(6)
    v_mfma_f32_32x32x16_bf16 v[224:239], v[48:51], v[128:131], v[224:239]
    ds_read_b64_tr_b16 v[76:77], v29 offset:14336
    ds_read_b64_tr_b16 v[78:79], v29 offset:15360
    v_cvt_pk_bf16_f32 v188, v168, v169
    v_cvt_pk_bf16_f32 v189, v170, v171
    buffer_store_dwordx4 v[184:187], v32, s[28:31], s44 offen sc1
    v_mfma_f32_32x32x16_bf16 v[224:239], v[52:55], v[132:135], v[224:239]
    s_barrier
    ds_read_b64_tr_b16 v[48:49], v28 offset:32768
    ds_read_b64_tr_b16 v[50:51], v28 offset:33792
    v_cvt_pk_bf16_f32 v190, v172, v173
    v_cvt_pk_bf16_f32 v191, v174, v175
    v_mfma_f32_32x32x16_bf16 v[224:239], v[56:59], v[136:139], v[224:239]
    ds_read_b64_tr_b16 v[52:53], v28 offset:34816
    ds_read_b64_tr_b16 v[54:55], v28 offset:35840
    buffer_store_dwordx4 v[188:191], v32, s[28:31], s44 offen offset:1024 sc1
    v_mfma_f32_32x32x16_bf16 v[224:239], v[60:63], v[140:143], v[224:239]
    ds_read_b64_tr_b16 v[56:57], v28 offset:36864
    ds_read_b64_tr_b16 v[58:59], v28 offset:37888
    s_waitcnt lgkmcnt(6)
    v_mfma_f32_32x32x16_bf16 v[224:239], v[64:67], v[144:147], v[224:239]
    ds_read_b64_tr_b16 v[60:61], v28 offset:38912
    ds_read_b64_tr_b16 v[62:63], v28 offset:39936
    v_mfma_f32_32x32x16_bf16 v[224:239], v[68:71], v[148:151], v[224:239]
    ds_read_b64_tr_b16 v[64:65], v28 offset:40960
    ds_read_b64_tr_b16 v[66:67], v28 offset:41984
    v_mfma_f32_32x32x16_bf16 v[224:239], v[72:75], v[152:155], v[224:239]
    ds_read_b64_tr_b16 v[68:69], v28 offset:43008
    ds_read_b64_tr_b16 v[70:71], v28 offset:44032
    v_mfma_f32_32x32x16_bf16 v[224:239], v[76:79], v[156:159], v[224:239]
    ds_read_b64_tr_b16 v[72:73], v28 offset:45056
    ds_read_b64_tr_b16 v[74:75], v28 offset:46080
    s_waitcnt lgkmcnt(6)
    v_mfma_f32_32x32x16_bf16 v[160:175], v[48:51], v[192:195], 0
    ds_read_b64_tr_b16 v[76:77], v28 offset:47104
    ds_read_b64_tr_b16 v[78:79], v28 offset:48128
    v_mfma_f32_32x32x16_bf16 v[160:175], v[52:55], v[196:199], v[160:175]
    ds_read_b64_tr_b16 v[48:49], v29 offset:32768
    ds_read_b64_tr_b16 v[50:51], v29 offset:33792
    v_mfma_f32_32x32x16_bf16 v[160:175], v[56:59], v[200:203], v[160:175]
    ds_read_b64_tr_b16 v[52:53], v29 offset:34816
    ds_read_b64_tr_b16 v[54:55], v29 offset:35840
    s_add_u32 s45, s42, 0
    s_and_b32 s45, s45, 7
    s_lshl_b32 s45, s45, 8
    s_waitcnt vmcnt(2)
    buffer_store_dword v240, v33, s[28:31], s45 offen sc1
    v_mfma_f32_32x32x16_bf16 v[160:175], v[60:63], v[204:207], v[160:175]
    ds_read_b64_tr_b16 v[56:57], v29 offset:36864
    ds_read_b64_tr_b16 v[58:59], v29 offset:37888
    s_waitcnt lgkmcnt(6)
    v_mfma_f32_32x32x16_bf16 v[160:175], v[64:67], v[208:211], v[160:175]
    ds_read_b64_tr_b16 v[60:61], v29 offset:38912
    ds_read_b64_tr_b16 v[62:63], v29 offset:39936
    v_mfma_f32_32x32x16_bf16 v[160:175], v[68:71], v[212:215], v[160:175]
    ds_read_b64_tr_b16 v[64:65], v29 offset:40960
    ds_read_b64_tr_b16 v[66:67], v29 offset:41984
    s_add_u32 s43, s42, 2
    s_and_b32 s43, s43, 7
    s_lshl_b32 s44, s43, 17
    s_add_u32 s44, s44, 16384
    v_mfma_f32_32x32x16_bf16 v[160:175], v[72:75], v[216:219], v[160:175]
    ds_read_b64_tr_b16 v[68:69], v29 offset:43008
    ds_read_b64_tr_b16 v[70:71], v29 offset:44032
    v_cvt_pk_bf16_f32 v176, v224, v225
    v_cvt_pk_bf16_f32 v177, v226, v227
    v_mfma_f32_32x32x16_bf16 v[160:175], v[76:79], v[220:223], v[160:175]
    ds_read_b64_tr_b16 v[72:73], v29 offset:45056
    ds_read_b64_tr_b16 v[74:75], v29 offset:46080
    v_cvt_pk_bf16_f32 v178, v228, v229
    v_cvt_pk_bf16_f32 v179, v230, v231
    s_waitcnt lgkmcnt(6)
    v_mfma_f32_32x32x16_bf16 v[160:175], v[48:51], v[128:131], v[160:175]
    ds_read_b64_tr_b16 v[76:77], v29 offset:47104
    ds_read_b64_tr_b16 v[78:79], v29 offset:48128
    v_cvt_pk_bf16_f32 v180, v232, v233
    v_cvt_pk_bf16_f32 v181, v234, v235
    buffer_store_dwordx4 v[176:179], v32, s[28:31], s44 offen sc1
    v_mfma_f32_32x32x16_bf16 v[160:175], v[52:55], v[132:135], v[160:175]
    s_barrier
    ds_read_b64_tr_b16 v[48:49], v30
    ds_read_b64_tr_b16 v[50:51], v30 offset:1024
    v_cvt_pk_bf16_f32 v182, v236, v237
    v_cvt_pk_bf16_f32 v183, v238, v239
    v_mfma_f32_32x32x16_bf16 v[160:175], v[56:59], v[136:139], v[160:175]
    ds_read_b64_tr_b16 v[52:53], v30 offset:2048
    ds_read_b64_tr_b16 v[54:55], v30 offset:3072
    buffer_store_dwordx4 v[180:183], v32, s[28:31], s44 offen offset:1024 sc1
    v_mfma_f32_32x32x16_bf16 v[160:175], v[60:63], v[140:143], v[160:175]
    ds_read_b64_tr_b16 v[56:57], v30 offset:4096
    ds_read_b64_tr_b16 v[58:59], v30 offset:5120
    s_waitcnt lgkmcnt(6)
    v_mfma_f32_32x32x16_bf16 v[160:175], v[64:67], v[144:147], v[160:175]
    ds_read_b64_tr_b16 v[60:61], v30 offset:6144
    ds_read_b64_tr_b16 v[62:63], v30 offset:7168
    v_mfma_f32_32x32x16_bf16 v[160:175], v[68:71], v[148:151], v[160:175]
    ds_read_b64_tr_b16 v[64:65], v30 offset:8192
    ds_read_b64_tr_b16 v[66:67], v30 offset:9216
    s_add_u32 s45, s42, 1
    s_and_b32 s45, s45, 7
    s_lshl_b32 s45, s45, 8
    s_waitcnt vmcnt(3)
    buffer_store_dword v240, v33, s[28:31], s45 offen offset:16 sc1
    v_mfma_f32_32x32x16_bf16 v[160:175], v[72:75], v[152:155], v[160:175]
    ds_read_b64_tr_b16 v[68:69], v30 offset:10240
    ds_read_b64_tr_b16 v[70:71], v30 offset:11264
    v_mfma_f32_32x32x16_bf16 v[160:175], v[76:79], v[156:159], v[160:175]
    ds_read_b64_tr_b16 v[72:73], v30 offset:12288
    ds_read_b64_tr_b16 v[74:75], v30 offset:13312
    s_waitcnt lgkmcnt(6)
    v_mfma_f32_32x32x16_bf16 v[224:239], v[48:51], v[192:195], 0
    ds_read_b64_tr_b16 v[76:77], v30 offset:14336
    ds_read_b64_tr_b16 v[78:79], v30 offset:15360
    v_mfma_f32_32x32x16_bf16 v[224:239], v[52:55], v[196:199], v[224:239]
    ds_read_b64_tr_b16 v[48:49], v31
    ds_read_b64_tr_b16 v[50:51], v31 offset:1024
    v_mfma_f32_32x32x16_bf16 v[224:239], v[56:59], v[200:203], v[224:239]
    ds_read_b64_tr_b16 v[52:53], v31 offset:2048
    ds_read_b64_tr_b16 v[54:55], v31 offset:3072
    v_mfma_f32_32x32x16_bf16 v[224:239], v[60:63], v[204:207], v[224:239]
    ds_read_b64_tr_b16 v[56:57], v31 offset:4096
    ds_read_b64_tr_b16 v[58:59], v31 offset:5120
    s_waitcnt lgkmcnt(6)
    v_mfma_f32_32x32x16_bf16 v[224:239], v[64:67], v[208:211], v[224:239]
    ds_read_b64_tr_b16 v[60:61], v31 offset:6144
    ds_read_b64_tr_b16 v[62:63], v31 offset:7168
    v_mfma_f32_32x32x16_bf16 v[224:239], v[68:71], v[212:215], v[224:239]
    ds_read_b64_tr_b16 v[64:65], v31 offset:8192
    ds_read_b64_tr_b16 v[66:67], v31 offset:9216
    s_add_u32 s43, s42, 3
    s_and_b32 s43, s43, 7
    s_lshl_b32 s44, s43, 17
    s_add_u32 s44, s44, 24576
    v_mfma_f32_32x32x16_bf16 v[224:239], v[72:75], v[216:219], v[224:239]
    ds_read_b64_tr_b16 v[68:69], v31 offset:10240
    ds_read_b64_tr_b16 v[70:71], v31 offset:11264
    v_cvt_pk_bf16_f32 v184, v160, v161
    v_cvt_pk_bf16_f32 v185, v162, v163
    v_mfma_f32_32x32x16_bf16 v[224:239], v[76:79], v[220:223], v[224:239]
    ds_read_b64_tr_b16 v[72:73], v31 offset:12288
    ds_read_b64_tr_b16 v[74:75], v31 offset:13312
    v_cvt_pk_bf16_f32 v186, v164, v165
    v_cvt_pk_bf16_f32 v187, v166, v167
    s_waitcnt lgkmcnt(6)
    v_mfma_f32_32x32x16_bf16 v[224:239], v[48:51], v[128:131], v[224:239]
    ds_read_b64_tr_b16 v[76:77], v31 offset:14336
    ds_read_b64_tr_b16 v[78:79], v31 offset:15360
    v_cvt_pk_bf16_f32 v188, v168, v169
    v_cvt_pk_bf16_f32 v189, v170, v171
    buffer_store_dwordx4 v[184:187], v32, s[28:31], s44 offen sc1
    v_mfma_f32_32x32x16_bf16 v[224:239], v[52:55], v[132:135], v[224:239]
    s_barrier
    ds_read_b64_tr_b16 v[48:49], v26
    ds_read_b64_tr_b16 v[50:51], v26 offset:1024
    v_cvt_pk_bf16_f32 v190, v172, v173
    v_cvt_pk_bf16_f32 v191, v174, v175
    v_mfma_f32_32x32x16_bf16 v[224:239], v[56:59], v[136:139], v[224:239]
    ds_read_b64_tr_b16 v[52:53], v26 offset:2048
    ds_read_b64_tr_b16 v[54:55], v26 offset:3072
    buffer_store_dwordx4 v[188:191], v32, s[28:31], s44 offen offset:1024 sc1
    v_mfma_f32_32x32x16_bf16 v[224:239], v[60:63], v[140:143], v[224:239]
    ds_read_b64_tr_b16 v[56:57], v26 offset:4096
    ds_read_b64_tr_b16 v[58:59], v26 offset:5120
    s_waitcnt lgkmcnt(6)
    v_mfma_f32_32x32x16_bf16 v[224:239], v[64:67], v[144:147], v[224:239]
    ds_read_b64_tr_b16 v[60:61], v26 offset:6144
    ds_read_b64_tr_b16 v[62:63], v26 offset:7168
    v_mfma_f32_32x32x16_bf16 v[224:239], v[68:71], v[148:151], v[224:239]
    ds_read_b64_tr_b16 v[64:65], v26 offset:8192
    ds_read_b64_tr_b16 v[66:67], v26 offset:9216
    s_add_u32 s45, s42, 2
    s_and_b32 s45, s45, 7
    s_lshl_b32 s45, s45, 8
    s_waitcnt vmcnt(3)
    buffer_store_dword v240, v33, s[28:31], s45 offen offset:32 sc1
    v_mfma_f32_32x32x16_bf16 v[224:239], v[72:75], v[152:155], v[224:239]
    ds_read_b64_tr_b16 v[68:69], v26 offset:10240
    ds_read_b64_tr_b16 v[70:71], v26 offset:11264
    v_mfma_f32_32x32x16_bf16 v[224:239], v[76:79], v[156:159], v[224:239]
    ds_read_b64_tr_b16 v[72:73], v26 offset:12288
    ds_read_b64_tr_b16 v[74:75], v26 offset:13312
    s_waitcnt lgkmcnt(6)
    v_mfma_f32_32x32x16_bf16 v[160:175], v[48:51], v[192:195], 0
    ds_read_b64_tr_b16 v[76:77], v26 offset:14336
    ds_read_b64_tr_b16 v[78:79], v26 offset:15360
    v_mfma_f32_32x32x16_bf16 v[160:175], v[52:55], v[196:199], v[160:175]
    ds_read_b64_tr_b16 v[48:49], v27
    ds_read_b64_tr_b16 v[50:51], v27 offset:1024
    v_mfma_f32_32x32x16_bf16 v[160:175], v[56:59], v[200:203], v[160:175]
    ds_read_b64_tr_b16 v[52:53], v27 offset:2048
    ds_read_b64_tr_b16 v[54:55], v27 offset:3072
    v_mfma_f32_32x32x16_bf16 v[160:175], v[60:63], v[204:207], v[160:175]
    ds_read_b64_tr_b16 v[56:57], v27 offset:4096
    ds_read_b64_tr_b16 v[58:59], v27 offset:5120
    s_waitcnt lgkmcnt(6)
    v_mfma_f32_32x32x16_bf16 v[160:175], v[64:67], v[208:211], v[160:175]
L_mk6:
    s_cbranch_execz L_rt6
    ds_read_b64_tr_b16 v[60:61], v27 offset:6144
    ds_read_b64_tr_b16 v[62:63], v27 offset:7168
    v_mfma_f32_32x32x16_bf16 v[160:175], v[68:71], v[212:215], v[160:175]
    ds_read_b64_tr_b16 v[64:65], v27 offset:8192
    ds_read_b64_tr_b16 v[66:67], v27 offset:9216
    s_add_u32 s43, s42, 4
    s_and_b32 s43, s43, 7
    s_lshl_b32 s44, s43, 17
    s_add_u32 s44, s44, 32768
    v_mfma_f32_32x32x16_bf16 v[160:175], v[72:75], v[216:219], v[160:175]
    ds_read_b64_tr_b16 v[68:69], v27 offset:10240
    ds_read_b64_tr_b16 v[70:71], v27 offset:11264
    v_cvt_pk_bf16_f32 v176, v224, v225
    v_cvt_pk_bf16_f32 v177, v226, v227
    v_mfma_f32_32x32x16_bf16 v[160:175], v[76:79], v[220:223], v[160:175]
    ds_read_b64_tr_b16 v[72:73], v27 offset:12288
    ds_read_b64_tr_b16 v[74:75], v27 offset:13312
    v_cvt_pk_bf16_f32 v178, v228, v229
    v_cvt_pk_bf16_f32 v179, v230, v231
    s_waitcnt lgkmcnt(6)
    v_mfma_f32_32x32x16_bf16 v[160:175], v[48:51], v[128:131], v[160:175]
    ds_read_b64_tr_b16 v[76:77], v27 offset:14336
    ds_read_b64_tr_b16 v[78:79], v27 offset:15360
    v_cvt_pk_bf16_f32 v180, v232, v233
    v_cvt_pk_bf16_f32 v181, v234, v235
    buffer_store_dwordx4 v[176:179], v32, s[28:31], s44 offen sc1
    v_mfma_f32_32x32x16_bf16 v[160:175], v[52:55], v[132:135], v[160:175]
    s_barrier
    ds_read_b64_tr_b16 v[48:49], v26 offset:32768
    ds_read_b64_tr_b16 v[50:51], v26 offset:33792
    v_cvt_pk_bf16_f32 v182, v236, v237
    v_cvt_pk_bf16_f32 v183, v238, v239
    v_mfma_f32_32x32x16_bf16 v[160:175], v[56:59], v[136:139], v[160:175]
    ds_read_b64_tr_b16 v[52:53], v26 offset:34816
    ds_read_b64_tr_b16 v[54:55], v26 offset:35840
    buffer_store_dwordx4 v[180:183], v32, s[28:31], s44 offen offset:1024 sc1
    v_mfma_f32_32x32x16_bf16 v[160:175], v[60:63], v[140:143], v[160:175]
    ds_read_b64_tr_b16 v[56:57], v26 offset:36864
    ds_read_b64_tr_b16 v[58:59], v26 offset:37888
    s_waitcnt lgkmcnt(6)
    v_mfma_f32_32x32x16_bf16 v[160:175], v[64:67], v[144:147], v[160:175]
    ds_read_b64_tr_b16 v[60:61], v26 offset:38912
    ds_read_b64_tr_b16 v[62:63], v26 offset:39936
    v_mfma_f32_32x32x16_bf16 v[160:175], v[68:71], v[148:151], v[160:175]
    ds_read_b64_tr_b16 v[64:65], v26 offset:40960
    ds_read_b64_tr_b16 v[66:67], v26 offset:41984
    v_mfma_f32_32x32x16_bf16 v[160:175], v[72:75], v[152:155], v[160:175]
    ds_read_b64_tr_b16 v[68:69], v26 offset:43008
    ds_read_b64_tr_b16 v[70:71], v26 offset:44032
    v_mfma_f32_32x32x16_bf16 v[160:175], v[76:79], v[156:159], v[160:175]
    ds_read_b64_tr_b16 v[72:73], v26 offset:45056
    ds_read_b64_tr_b16 v[74:75], v26 offset:46080
    s_waitcnt lgkmcnt(6)
    v_mfma_f32_32x32x16_bf16 v[224:239], v[48:51], v[192:195], 0
    ds_read_b64_tr_b16 v[76:77], v26 offset:47104
    ds_read_b64_tr_b16 v[78:79], v26 offset:48128
    v_mfma_f32_32x32x16_bf16 v[224:239], v[52:55], v[196:199], v[224:239]
    ds_read_b64_tr_b16 v[48:49], v27 offset:32768
    ds_read_b64_tr_b16 v[50:51], v27 offset:33792
    v_mfma_f32_32x32x16_bf16 v[224:239], v[56:59], v[200:203], v[224:239]
    ds_read_b64_tr_b16 v[52:53], v27 offset:34816
    ds_read_b64_tr_b16 v[54:55], v27 offset:35840
    v_mfma_f32_32x32x16_bf16 v[224:239], v[60:63], v[204:207], v[224:239]
    ds_read_b64_tr_b16 v[56:57], v27 offset:36864
    ds_read_b64_tr_b16 v[58:59], v27 offset:37888
    s_waitcnt lgkmcnt(6)
    v_mfma_f32_32x32x16_bf16 v[224:239], v[64:67], v[208:211], v[224:239]
    ds_read_b64_tr_b16 v[60:61], v27 offset:38912
    ds_read_b64_tr_b16 v[62:63], v27 offset:39936
    v_mfma_f32_32x32x16_bf16 v[224:239], v[68:71], v[212:215], v[224:239]
    ds_read_b64_tr_b16 v[64:65], v27 offset:40960
    ds_read_b64_tr_b16 v[66:67], v27 offset:41984
    s_add_u32 s43, s42, 5
    s_and_b32 s43, s43, 7
    s_lshl_b32 s44, s43, 17
    s_add_u32 s44, s44, 40960
    v_mfma_f32_32x32x16_bf16 v[224:239], v[72:75], v[216:219], v[224:239]
    ds_read_b64_tr_b16 v[68:69], v27 offset:43008
    ds_read_b64_tr_b16 v[70:71], v27 offset:44032
    v_cvt_pk_bf16_f32 v184, v160, v161
    v_cvt_pk_bf16_f32 v185, v162, v163
    v_mfma_f32_32x32x16_bf16 v[224:239], v[76:79], v[220:223], v[224:239]
    ds_read_b64_tr_b16 v[72:73], v27 offset:45056
    ds_read_b64_tr_b16 v[74:75], v27 offset:46080
    v_cvt_pk_bf16_f32 v186, v164, v165
    v_cvt_pk_bf16_f32 v187, v166, v167
    s_waitcnt lgkmcnt(6)
    v_mfma_f32_32x32x16_bf16 v[224:239], v[48:51], v[128:131], v[224:239]
    ds_read_b64_tr_b16 v[76:77], v27 offset:47104
    ds_read_b64_tr_b16 v[78:79], v27 offset:48128
    v_cvt_pk_bf16_f32 v188, v168, v169
    v_cvt_pk_bf16_f32 v189, v170, v171
    buffer_store_dwordx4 v[184:187], v32, s[28:31], s44 offen sc1
    v_mfma_f32_32x32x16_bf16 v[224:239], v[52:55], v[132:135], v[224:239]
    ds_read_b64_tr_b16 v[48:49], v28
    ds_read_b64_tr_b16 v[50:51], v28 offset:1024
    v_cvt_pk_bf16_f32 v190, v172, v173
    v_cvt_pk_bf16_f32 v191, v174, v175
    v_mfma_f32_32x32x16_bf16 v[224:239], v[56:59], v[136:139], v[224:239]
    ds_read_b64_tr_b16 v[52:53], v28 offset:2048
    ds_read_b64_tr_b16 v[54:55], v28 offset:3072
    buffer_store_dwordx4 v[188:191], v32, s[28:31], s44 offen offset:1024 sc1
    v_mfma_f32_32x32x16_bf16 v[224:239], v[60:63], v[140:143], v[224:239]
    ds_read_b64_tr_b16 v[56:57], v28 offset:4096
    ds_read_b64_tr_b16 v[58:59], v28 offset:5120
    s_waitcnt lgkmcnt(6)
    v_mfma_f32_32x32x16_bf16 v[224:239], v[64:67], v[144:147], v[224:239]
    ds_read_b64_tr_b16 v[60:61], v28 offset:6144
    ds_read_b64_tr_b16 v[62:63], v28 offset:7168
    v_mfma_f32_32x32x16_bf16 v[224:239], v[68:71], v[148:151], v[224:239]
    ds_read_b64_tr_b16 v[64:65], v28 offset:8192
    ds_read_b64_tr_b16 v[66:67], v28 offset:9216
    v_mfma_f32_32x32x16_bf16 v[224:239], v[72:75], v[152:155], v[224:239]
    ds_read_b64_tr_b16 v[68:69], v28 offset:10240
    ds_read_b64_tr_b16 v[70:71], v28 offset:11264
    v_mfma_f32_32x32x16_bf16 v[224:239], v[76:79], v[156:159], v[224:239]
    ds_read_b64_tr_b16 v[72:73], v28 offset:12288
    ds_read_b64_tr_b16 v[74:75], v28 offset:13312
    s_waitcnt lgkmcnt(6)
    v_mfma_f32_32x32x16_bf16 v[160:175], v[48:51], v[192:195], 0
    ds_read_b64_tr_b16 v[76:77], v28 offset:14336
    ds_read_b64_tr_b16 v[78:79], v28 offset:15360
    v_mfma_f32_32x32x16_bf16 v[160:175], v[52:55], v[196:199], v[160:175]
    ds_read_b64_tr_b16 v[48:49], v29
    ds_read_b64_tr_b16 v[50:51], v29 offset:1024
    v_mfma_f32_32x32x16_bf16 v[160:175], v[56:59], v[200:203], v[160:175]
    ds_read_b64_tr_b16 v[52:53], v29 offset:2048
    ds_read_b64_tr_b16 v[54:55], v29 offset:3072
    v_mfma_f32_32x32x16_bf16 v[160:175], v[60:63], v[204:207], v[160:175]
    ds_read_b64_tr_b16 v[56:57], v29 offset:4096
    ds_read_b64_tr_b16 v[58:59], v29 offset:5120
    s_waitcnt lgkmcnt(6)
    v_mfma_f32_32x32x16_bf16 v[160:175], v[64:67], v[208:211], v[160:175]
    ds_read_b64_tr_b16 v[60:61], v29 offset:6144
    ds_read_b64_tr_b16 v[62:63], v29 offset:7168
    v_mfma_f32_32x32x16_bf16 v[160:175], v[68:71], v[212:215], v[160:175]
    ds_read_b64_tr_b16 v[64:65], v29 offset:8192
    ds_read_b64_tr_b16 v[66:67], v29 offset:9216
    s_add_u32 s43, s42, 6
    s_and_b32 s43, s43, 7
    s_lshl_b32 s44, s43, 17
    s_add_u32 s44, s44, 49152
    v_mfma_f32_32x32x16_bf16 v[160:175], v[72:75], v[216:219], v[160:175]
    ds_read_b64_tr_b16 v[68:69], v29 offset:10240
    ds_read_b64_tr_b16 v[70:71], v29 offset:11264
    v_cvt_pk_bf16_f32 v176, v224, v225
    v_cvt_pk_bf16_f32 v177, v226, v227
    v_mfma_f32_32x32x16_bf16 v[160:175], v[76:79], v[220:223], v[160:175]
    ds_read_b64_tr_b16 v[72:73], v29 offset:12288
    ds_read_b64_tr_b16 v[74:75], v29 offset:13312
    v_cvt_pk_bf16_f32 v178, v228, v229
    v_cvt_pk_bf16_f32 v179, v230, v231
    s_waitcnt lgkmcnt(6)
    v_mfma_f32_32x32x16_bf16 v[160:175], v[48:51], v[128:131], v[160:175]
    ds_read_b64_tr_b16 v[76:77], v29 offset:14336
    ds_read_b64_tr_b16 v[78:79], v29 offset:15360
    v_cvt_pk_bf16_f32 v180, v232, v233
    v_cvt_pk_bf16_f32 v181, v234, v235
    buffer_store_dwordx4 v[176:179], v32, s[28:31], s44 offen sc1
    v_mfma_f32_32x32x16_bf16 v[160:175], v[52:55], v[132:135], v[160:175]
    v_cvt_pk_bf16_f32 v182, v236, v237
    v_cvt_pk_bf16_f32 v183, v238, v239
    v_mfma_f32_32x32x16_bf16 v[160:175], v[56:59], v[136:139], v[160:175]
    buffer_store_dwordx4 v[180:183], v32, s[28:31], s44 offen offset:1024 sc1
    v_mfma_f32_32x32x16_bf16 v[160:175], v[60:63], v[140:143], v[160:175]
    s_waitcnt lgkmcnt(0)
    v_mfma_f32_32x32x16_bf16 v[160:175], v[64:67], v[144:147], v[160:175]
    v_mfma_f32_32x32x16_bf16 v[160:175], v[68:71], v[148:151], v[160:175]
    v_mfma_f32_32x32x16_bf16 v[160:175], v[72:75], v[152:155], v[160:175]
    v_mfma_f32_32x32x16_bf16 v[160:175], v[76:79], v[156:159], v[160:175]
    s_and_b32 s43, s7, 1
    s_and_b32 s44, s3, 1
    s_cmp_eq_u32 s43, s44
    s_cbranch_scc1 L_own
    s_add_u32 s43, s42, 7
    s_and_b32 s43, s43, 7
    s_lshl_b32 s44, s43, 17
    s_add_u32 s44, s44, 57344
    s_nop 3
    v_cvt_pk_bf16_f32 v184, v160, v161
    v_cvt_pk_bf16_f32 v185, v162, v163
    v_cvt_pk_bf16_f32 v186, v164, v165
    v_cvt_pk_bf16_f32 v187, v166, v167
    v_cvt_pk_bf16_f32 v188, v168, v169
    v_cvt_pk_bf16_f32 v189, v170, v171
    v_cvt_pk_bf16_f32 v190, v172, v173
    v_cvt_pk_bf16_f32 v191, v174, v175
    buffer_store_dwordx4 v[184:187], v32, s[28:31], s44 offen sc1
    buffer_store_dwordx4 v[188:191], v32, s[28:31], s44 offen offset:1024 sc1
    s_barrier
    s_add_u32 s45, s42, 3
    s_and_b32 s45, s45, 7
    s_lshl_b32 s45, s45, 8
    s_waitcnt vmcnt(9)
    buffer_store_dword v240, v33, s[28:31], s45 offen offset:48 sc1
    s_add_u32 s45, s42, 4
    s_and_b32 s45, s45, 7
    s_lshl_b32 s45, s45, 8
    s_waitcnt vmcnt(7)
    buffer_store_dword v240, v33, s[28:31], s45 offen offset:64 sc1
    s_add_u32 s45, s42, 5
    s_and_b32 s45, s45, 7
    s_lshl_b32 s45, s45, 8
    s_waitcnt vmcnt(6)
    buffer_store_dword v240, v33, s[28:31], s45 offen offset:80 sc1
    s_add_u32 s45, s42, 6
    s_and_b32 s45, s45, 7
    s_lshl_b32 s45, s45, 8
    s_waitcnt vmcnt(5)
    buffer_store_dword v240, v33, s[28:31], s45 offen offset:96 sc1
    s_add_u32 s45, s42, 7
    s_and_b32 s45, s45, 7
    s_lshl_b32 s45, s45, 8
    s_waitcnt vmcnt(4)
    buffer_store_dword v240, v33, s[28:31], s45 offen offset:112 sc1
    s_branch L_fin
L_own:
    s_lshr_b32 s43, s3, 1
    s_lshl_b32 s43, s43, 12
    s_add_u32 s43, s43, 98304
    v_lshl_add_u32 v38, v1, 4, s43
    s_nop 3
    ds_write_b128 v38, v[160:163]
    ds_write_b128 v38, v[164:167] offset:1024
    ds_write_b128 v38, v[168:171] offset:2048
    ds_write_b128 v38, v[172:175] offset:3072
    s_waitcnt lgkmcnt(0)
    s_barrier
    s_add_u32 s45, s42, 3
    s_and_b32 s45, s45, 7
    s_lshl_b32 s45, s45, 8
    s_waitcnt vmcnt(7)
    buffer_store_dword v240, v33, s[28:31], s45 offen offset:48 sc1
    s_add_u32 s45, s42, 4
    s_and_b32 s45, s45, 7
    s_lshl_b32 s45, s45, 8
    s_waitcnt vmcnt(5)
    buffer_store_dword v240, v33, s[28:31], s45 offen offset:64 sc1
    s_add_u32 s45, s42, 5
    s_and_b32 s45, s45, 7
    s_lshl_b32 s45, s45, 8
    s_waitcnt vmcnt(4)
    buffer_store_dword v240, v33, s[28:31], s45 offen offset:80 sc1
    s_add_u32 s45, s42, 6
    s_and_b32 s45, s45, 7
    s_lshl_b32 s45, s45, 8
    s_waitcnt vmcnt(3)
    buffer_store_dword v240, v33, s[28:31], s45 offen offset:96 sc1
    s_waitcnt lgkmcnt(0)
L_fin:
    s_endpgm
L_slow:
    s_waitcnt vmcnt(0) lgkmcnt(0)
    s_nop 15
    s_barrier
    s_mov_b32 s53, 1
    s_lshr_b32 s43, s6, 1
    s_lshl_b32 s44, s5, 3
    s_add_u32 s43, s43, s44
    s_lshl_b32 s43, s43, 17
    v_and_b32 v45, 31, v1
    v_lshrrev_b32 v44, 5, v1
    v_lshlrev_b32 v38, 8, v45
    v_lshl_add_u32 v38, v44, 4, v38
    v_add_u32 v38, s43, v38
    v_lshlrev_b32 v39, 10, v44
    v_lshl_add_u32 v39, v45, 1, v39
    v_add_u32 v39, s43, v39
    v_mov_b32 v44, 0xff800000
    s_mov_b32 s44, 0
L_s1:
    s_nop 11
    buffer_load_dwordx4 v[48:51], v38, s[12:15], s44 offen
    buffer_load_dwordx4 v[52:55], v38, s[12:15], s44 offen offset:32
    buffer_load_dwordx4 v[56:59], v38, s[12:15], s44 offen offset:64
    buffer_load_dwordx4 v[60:63], v38, s[12:15], s44 offen offset:96
    buffer_load_dwordx4 v[64:67], v38, s[12:15], s44 offen offset:128
    buffer_load_dwordx4 v[68:71], v38, s[12:15], s44 offen offset:160
    buffer_load_dwordx4 v[72:75], v38, s[12:15], s44 offen offset:192
    buffer_load_dwordx4 v[76:79], v38, s[12:15], s44 offen offset:224
    s_waitcnt vmcnt(0)
    v_mfma_f32_32x32x16_bf16 v[192:207], v[48:51], v[92:95], 0
    v_mfma_f32_32x32x16_bf16 v[192:207], v[52:55], v[96:99], v[192:207]
    v_mfma_f32_32x32x16_bf16 v[192:207], v[56:59], v[100:103], v[192:207]
    v_mfma_f32_32x32x16_bf16 v[192:207], v[60:63], v[104:107], v[192:207]
    v_mfma_f32_32x32x16_bf16 v[192:207], v[64:67], v[108:111], v[192:207]
    v_mfma_f32_32x32x16_bf16 v[192:207], v[68:71], v[112:115], v[192:207]
    v_mfma_f32_32x32x16_bf16 v[192:207], v[72:75], v[116:119], v[192:207]
    v_mfma_f32_32x32x16_bf16 v[192:207], v[76:79], v[120:123], v[192:207]
    s_nop 11
    v_max3_f32 v44, v44, v192, v193
    v_max3_f32 v44, v44, v194, v195
    v_max3_f32 v44, v44, v196, v197
    v_max3_f32 v44, v44, v198, v199
    v_max3_f32 v44, v44, v200, v201
    v_max3_f32 v44, v44, v202, v203
    v_max3_f32 v44, v44, v204, v205
    v_max3_f32 v44, v44, v206, v207
    s_add_u32 s44, s44, 8192
    s_cmp_lt_u32 s44, 0x20000
    s_cbranch_scc1 L_s1
    v_mov_b32 v45, v44
    s_nop 1
    v_permlane32_swap_b32 v44, v45
    v_max_f32 v44, v44, v45
    v_sub_f32 v224, 0, v44
    v_sub_f32 v225, 0, v44
    v_sub_f32 v226, 0, v44
    v_sub_f32 v227, 0, v44
    v_sub_f32 v228, 0, v44
    v_sub_f32 v229, 0, v44
    v_sub_f32 v230, 0, v44
    v_sub_f32 v231, 0, v44
    v_sub_f32 v232, 0, v44
    v_sub_f32 v233, 0, v44
    v_sub_f32 v234, 0, v44
    v_sub_f32 v235, 0, v44
    v_sub_f32 v236, 0, v44
    v_sub_f32 v237, 0, v44
    v_sub_f32 v238, 0, v44
    v_sub_f32 v239, 0, v44
    v_mov_b32 v128, 0
    v_mov_b32 v129, 0
    v_mov_b32 v130, 0
    v_mov_b32 v131, 0
    v_mov_b32 v132, 0
    v_mov_b32 v133, 0
    v_mov_b32 v134, 0
    v_mov_b32 v135, 0
    v_mov_b32 v136, 0
    v_mov_b32 v137, 0
    v_mov_b32 v138, 0
    v_mov_b32 v139, 0
    v_mov_b32 v140, 0
    v_mov_b32 v141, 0
    v_mov_b32 v142, 0
    v_mov_b32 v143, 0
    v_mov_b32 v144, 0
    v_mov_b32 v145, 0
    v_mov_b32 v146, 0
    v_mov_b32 v147, 0
    v_mov_b32 v148, 0
    v_mov_b32 v149, 0
    v_mov_b32 v150, 0
    v_mov_b32 v151, 0
    v_mov_b32 v152, 0
    v_mov_b32 v153, 0
    v_mov_b32 v154, 0
    v_mov_b32 v155, 0
    v_mov_b32 v156, 0
    v_mov_b32 v157, 0
    v_mov_b32 v158, 0
    v_mov_b32 v159, 0
    v_mov_b32 v160, 0
    v_mov_b32 v161, 0
    v_mov_b32 v162, 0
    v_mov_b32 v163, 0
    v_mov_b32 v164, 0
    v_mov_b32 v165, 0
    v_mov_b32 v166, 0
    v_mov_b32 v167, 0
    v_mov_b32 v168, 0
    v_mov_b32 v169, 0
    v_mov_b32 v170, 0
    v_mov_b32 v171, 0
    v_mov_b32 v172, 0
    v_mov_b32 v173, 0
    v_mov_b32 v174, 0
    v_mov_b32 v175, 0
    v_mov_b32 v176, 0
    v_mov_b32 v177, 0
    v_mov_b32 v178, 0
    v_mov_b32 v179, 0
    v_mov_b32 v180, 0
    v_mov_b32 v181, 0
    v_mov_b32 v182, 0
    v_mov_b32 v183, 0
    v_mov_b32 v184, 0
    v_mov_b32 v185, 0
    v_mov_b32 v186, 0
    v_mov_b32 v187, 0
    v_mov_b32 v188, 0
    v_mov_b32 v189, 0
    v_mov_b32 v190, 0
    v_mov_b32 v191, 0
    v_mov_b32 v36, 0
    v_mov_b32 v37, 0
    s_mov_b32 s44, 0
L_s2:
    s_nop 11
    buffer_load_dwordx4 v[48:51], v38, s[12:15], s44 offen
    buffer_load_dwordx4 v[52:55], v38, s[12:15], s44 offen offset:32
    buffer_load_dwordx4 v[56:59], v38, s[12:15], s44 offen offset:64
    buffer_load_dwordx4 v[60:63], v38, s[12:15], s44 offen offset:96
    buffer_load_dwordx4 v[64:67], v38, s[12:15], s44 offen offset:128
    buffer_load_dwordx4 v[68:71], v38, s[12:15], s44 offen offset:160
    buffer_load_dwordx4 v[72:75], v38, s[12:15], s44 offen offset:192
    buffer_load_dwordx4 v[76:79], v38, s[12:15], s44 offen offset:224
    s_waitcnt vmcnt(0)
    v_mfma_f32_32x32x16_bf16 v[192:207], v[48:51], v[92:95], v[224:239]
    v_mfma_f32_32x32x16_bf16 v[192:207], v[52:55], v[96:99], v[192:207]
    v_mfma_f32_32x32x16_bf16 v[192:207], v[56:59], v[100:103], v[192:207]
    v_mfma_f32_32x32x16_bf16 v[192:207], v[60:63], v[104:107], v[192:207]
    v_mfma_f32_32x32x16_bf16 v[192:207], v[64:67], v[108:111], v[192:207]
    v_mfma_f32_32x32x16_bf16 v[192:207], v[68:71], v[112:115], v[192:207]
    v_mfma_f32_32x32x16_bf16 v[192:207], v[72:75], v[116:119], v[192:207]
    v_mfma_f32_32x32x16_bf16 v[192:207], v[76:79], v[120:123], v[192:207]
    s_nop 11
    v_exp_f32 v192, v192
    v_exp_f32 v193, v193
    v_exp_f32 v194, v194
    v_exp_f32 v195, v195
    v_exp_f32 v196, v196
    v_exp_f32 v197, v197
    v_exp_f32 v198, v198
    v_exp_f32 v199, v199
    v_exp_f32 v200, v200
    v_exp_f32 v201, v201
    v_exp_f32 v202, v202
    v_exp_f32 v203, v203
    v_exp_f32 v204, v204
    v_exp_f32 v205, v205
    v_exp_f32 v206, v206
    v_exp_f32 v207, v207
    v_add_f32 v36, v36, v192
    v_add_f32 v36, v36, v193
    v_add_f32 v36, v36, v194
    v_add_f32 v36, v36, v195
    v_add_f32 v36, v36, v196
    v_add_f32 v36, v36, v197
    v_add_f32 v36, v36, v198
    v_add_f32 v36, v36, v199
    v_add_f32 v36, v36, v200
    v_add_f32 v36, v36, v201
    v_add_f32 v36, v36, v202
    v_add_f32 v36, v36, v203
    v_add_f32 v36, v36, v204
    v_add_f32 v36, v36, v205
    v_add_f32 v36, v36, v206
    v_add_f32 v36, v36, v207
    v_cvt_pk_bf16_f32 v80, v192, v193
    v_cvt_pk_bf16_f32 v81, v194, v195
    v_cvt_pk_bf16_f32 v82, v196, v197
    v_cvt_pk_bf16_f32 v83, v198, v199
    v_cvt_pk_bf16_f32 v84, v200, v201
    v_cvt_pk_bf16_f32 v85, v202, v203
    v_cvt_pk_bf16_f32 v86, v204, v205
    v_cvt_pk_bf16_f32 v87, v206, v207
    s_add_u32 s45, s44, 0
    buffer_load_ushort v208, v39, s[16:19], s45 offen
    buffer_load_ushort v209, v39, s[16:19], s45 offen offset:256
    buffer_load_ushort v210, v39, s[16:19], s45 offen offset:512
    buffer_load_ushort v211, v39, s[16:19], s45 offen offset:768
    buffer_load_ushort v212, v39, s[16:19], s45 offen offset:2048
    buffer_load_ushort v213, v39, s[16:19], s45 offen offset:2304
    buffer_load_ushort v214, v39, s[16:19], s45 offen offset:2560
    buffer_load_ushort v215, v39, s[16:19], s45 offen offset:2816
    s_waitcnt vmcnt(0)
    v_lshl_or_b32 v48, v209, 16, v208
    v_lshl_or_b32 v49, v211, 16, v210
    v_lshl_or_b32 v50, v213, 16, v212
    v_lshl_or_b32 v51, v215, 16, v214
    buffer_load_ushort v208, v39, s[16:19], s45 offen offset:64
    buffer_load_ushort v209, v39, s[16:19], s45 offen offset:320
    buffer_load_ushort v210, v39, s[16:19], s45 offen offset:576
    buffer_load_ushort v211, v39, s[16:19], s45 offen offset:832
    buffer_load_ushort v212, v39, s[16:19], s45 offen offset:2112
    buffer_load_ushort v213, v39, s[16:19], s45 offen offset:2368
    buffer_load_ushort v214, v39, s[16:19], s45 offen offset:2624
    buffer_load_ushort v215, v39, s[16:19], s45 offen offset:2880
    s_waitcnt vmcnt(0)
    v_lshl_or_b32 v52, v209, 16, v208
    v_lshl_or_b32 v53, v211, 16, v210
    v_lshl_or_b32 v54, v213, 16, v212
    v_lshl_or_b32 v55, v215, 16, v214
    buffer_load_ushort v208, v39, s[16:19], s45 offen offset:128
    buffer_load_ushort v209, v39, s[16:19], s45 offen offset:384
    buffer_load_ushort v210, v39, s[16:19], s45 offen offset:640
    buffer_load_ushort v211, v39, s[16:19], s45 offen offset:896
    buffer_load_ushort v212, v39, s[16:19], s45 offen offset:2176
    buffer_load_ushort v213, v39, s[16:19], s45 offen offset:2432
    buffer_load_ushort v214, v39, s[16:19], s45 offen offset:2688
    buffer_load_ushort v215, v39, s[16:19], s45 offen offset:2944
    s_waitcnt vmcnt(0)
    v_lshl_or_b32 v56, v209, 16, v208
    v_lshl_or_b32 v57, v211, 16, v210
    v_lshl_or_b32 v58, v213, 16, v212
    v_lshl_or_b32 v59, v215, 16, v214
    buffer_load_ushort v208, v39, s[16:19], s45 offen offset:192
    buffer_load_ushort v209, v39, s[16:19], s45 offen offset:448
    buffer_load_ushort v210, v39, s[16:19], s45 offen offset:704
    buffer_load_ushort v211, v39, s[16:19], s45 offen offset:960
    buffer_load_ushort v212, v39, s[16:19], s45 offen offset:2240
    buffer_load_ushort v213, v39, s[16:19], s45 offen offset:2496
    buffer_load_ushort v214, v39, s[16:19], s45 offen offset:2752
    buffer_load_ushort v215, v39, s[16:19], s45 offen offset:3008
    s_waitcnt vmcnt(0)
    v_lshl_or_b32 v60, v209, 16, v208
    v_lshl_or_b32 v61, v211, 16, v210
    v_lshl_or_b32 v62, v213, 16, v212
    v_lshl_or_b32 v63, v215, 16, v214
    v_mfma_f32_32x32x16_bf16 v[128:143], v[48:51], v[80:83], v[128:143]
    v_mfma_f32_32x32x16_bf16 v[144:159], v[52:55], v[80:83], v[144:159]
    v_mfma_f32_32x32x16_bf16 v[160:175], v[56:59], v[80:83], v[160:175]
    v_mfma_f32_32x32x16_bf16 v[176:191], v[60:63], v[80:83], v[176:191]
    s_nop 7
    s_add_u32 s45, s44, 4096
    buffer_load_ushort v208, v39, s[16:19], s45 offen
    buffer_load_ushort v209, v39, s[16:19], s45 offen offset:256
    buffer_load_ushort v210, v39, s[16:19], s45 offen offset:512
    buffer_load_ushort v211, v39, s[16:19], s45 offen offset:768
    buffer_load_ushort v212, v39, s[16:19], s45 offen offset:2048
    buffer_load_ushort v213, v39, s[16:19], s45 offen offset:2304
    buffer_load_ushort v214, v39, s[16:19], s45 offen offset:2560
    buffer_load_ushort v215, v39, s[16:19], s45 offen offset:2816
    s_waitcnt vmcnt(0)
    v_lshl_or_b32 v48, v209, 16, v208
    v_lshl_or_b32 v49, v211, 16, v210
    v_lshl_or_b32 v50, v213, 16, v212
    v_lshl_or_b32 v51, v215, 16, v214
    buffer_load_ushort v208, v39, s[16:19], s45 offen offset:64
    buffer_load_ushort v209, v39, s[16:19], s45 offen offset:320
    buffer_load_ushort v210, v39, s[16:19], s45 offen offset:576
    buffer_load_ushort v211, v39, s[16:19], s45 offen offset:832
    buffer_load_ushort v212, v39, s[16:19], s45 offen offset:2112
    buffer_load_ushort v213, v39, s[16:19], s45 offen offset:2368
    buffer_load_ushort v214, v39, s[16:19], s45 offen offset:2624
    buffer_load_ushort v215, v39, s[16:19], s45 offen offset:2880
    s_waitcnt vmcnt(0)
    v_lshl_or_b32 v52, v209, 16, v208
    v_lshl_or_b32 v53, v211, 16, v210
    v_lshl_or_b32 v54, v213, 16, v212
    v_lshl_or_b32 v55, v215, 16, v214
    buffer_load_ushort v208, v39, s[16:19], s45 offen offset:128
    buffer_load_ushort v209, v39, s[16:19], s45 offen offset:384
    buffer_load_ushort v210, v39, s[16:19], s45 offen offset:640
    buffer_load_ushort v211, v39, s[16:19], s45 offen offset:896
    buffer_load_ushort v212, v39, s[16:19], s45 offen offset:2176
    buffer_load_ushort v213, v39, s[16:19], s45 offen offset:2432
    buffer_load_ushort v214, v39, s[16:19], s45 offen offset:2688
    buffer_load_ushort v215, v39, s[16:19], s45 offen offset:2944
    s_waitcnt vmcnt(0)
    v_lshl_or_b32 v56, v209, 16, v208
    v_lshl_or_b32 v57, v211, 16, v210
    v_lshl_or_b32 v58, v213, 16, v212
    v_lshl_or_b32 v59, v215, 16, v214
    buffer_load_ushort v208, v39, s[16:19], s45 offen offset:192
    buffer_load_ushort v209, v39, s[16:19], s45 offen offset:448
    buffer_load_ushort v210, v39, s[16:19], s45 offen offset:704
    buffer_load_ushort v211, v39, s[16:19], s45 offen offset:960
    buffer_load_ushort v212, v39, s[16:19], s45 offen offset:2240
    buffer_load_ushort v213, v39, s[16:19], s45 offen offset:2496
    buffer_load_ushort v214, v39, s[16:19], s45 offen offset:2752
    buffer_load_ushort v215, v39, s[16:19], s45 offen offset:3008
    s_waitcnt vmcnt(0)
    v_lshl_or_b32 v60, v209, 16, v208
    v_lshl_or_b32 v61, v211, 16, v210
    v_lshl_or_b32 v62, v213, 16, v212
    v_lshl_or_b32 v63, v215, 16, v214
    v_mfma_f32_32x32x16_bf16 v[128:143], v[48:51], v[84:87], v[128:143]
    v_mfma_f32_32x32x16_bf16 v[144:159], v[52:55], v[84:87], v[144:159]
    v_mfma_f32_32x32x16_bf16 v[160:175], v[56:59], v[84:87], v[160:175]
    v_mfma_f32_32x32x16_bf16 v[176:191], v[60:63], v[84:87], v[176:191]
    s_nop 7
    s_add_u32 s44, s44, 8192
    s_cmp_lt_u32 s44, 0x20000
    s_cbranch_scc1 L_s2
    s_nop 15
    v_add_f32 v36, v36, v37
    v_mov_b32 v38, v36
    s_mov_b32 s43, 0x33800000
    s_mov_b32 s44, 0x4b800000
    v_permlane32_swap_b32 v36, v38
    v_add_f32 v36, v36, v38
    v_rcp_f32 v41, v36
    v_cmp_nle_f32 vcc, s43, v36
    v_cmp_nge_f32 s[56:57], s44, v36
    s_nop 1
    s_branch L_norm
L_end:
    s_endpgm
.section .rodata,"a"
.p2align 6
.amdhsa_kernel concat_heads__gqa_block_cached__gqa_block_cached__near_ridge_kernel
  .amdhsa_next_free_vgpr 248
  .amdhsa_next_free_sgpr 102
  .amdhsa_accum_offset 248
  .amdhsa_group_segment_fixed_size 0
  .amdhsa_kernarg_size 104
  .amdhsa_user_sgpr_count 2
  .amdhsa_user_sgpr_kernarg_segment_ptr 1
  .amdhsa_system_sgpr_workgroup_id_x 1
.end_amdhsa_kernel
```
